```python
import torch

def _softmax(x, axis=-1):
    return torch.softmax(x, dim=axis)
def _gelu(x):
    return torch.nn.functional.gelu(x, approximate="tanh")
def _silu(x):
    return torch.nn.functional.silu(x)
def _sigmoid(x):
    return torch.sigmoid(x)
def _layernorm(x, axis=-1, eps=1e-5):
    m = x.mean(dim=axis, keepdim=True)
    v = x.var(dim=axis, keepdim=True, unbiased=False)
    return (x - m) / torch.sqrt(v + eps)
def _scatter_add(tgt, idx, src, axis=0):
    return tgt.clone().index_add_(axis, idx, src)
def _segment_sum(src, seg, n):
    out = torch.zeros((n,) + src.shape[1:], dtype=src.dtype)
    return out.index_add_(0, seg, src)
def _pad(x, pw):
    flat = tuple(v for pair in reversed(pw) for v in pair)
    return torch.nn.functional.pad(x, flat)

kernel_name = 'standalone__mha_block_cached__near_ridge'

def setup_inputs():

    _w = (lambda a: (lambda t: t.to(torch.bfloat16) if t.is_floating_point() else t)(torch.as_tensor(a)))
    B, Sq, D = 8, 192, 640
    H, Sk, Dh = 32, 2048, 128
    return {
        "x": _w((lambda *s: torch.randn(*s, dtype=torch.bfloat16) * 0.8)(B, Sq, D)),
        "k_cache": _w((lambda *s: torch.randn(*s, dtype=torch.bfloat16) * 0.8)(B, H, Sk, Dh)),
        "v_cache": _w((lambda *s: torch.randn(*s, dtype=torch.bfloat16) * 0.05)(B, H, Sk, Dh)),
        "wq": _w((lambda *s: torch.randn(*s, dtype=torch.bfloat16) * 0.8)(D, H * Dh) * (D ** -0.5)),
        "wo": _w((lambda *s: torch.randn(*s, dtype=torch.bfloat16) * 0.05)(H * Dh, D) * ((H * Dh) ** -0.5)),
    }

def reference(x, k_cache, v_cache, wq, wo):
    B, Sq, D = x.shape
    H, Dh = 32, 128
    q = (lambda x, *d: x.permute(*d))((x @ wq).reshape(B, Sq, H, Dh), 0, 2, 1, 3)
    scores = torch.einsum("bhqd,bhkd->bhqk", q, k_cache) * (Dh ** -0.5)
    p = _softmax(scores, axis=-1)
    o = torch.einsum("bhqk,bhkd->bhqd", p, v_cache)
    return (lambda x, *d: x.permute(*d))(o, 0, 2, 1, 3).reshape(B, Sq, H * Dh) @ wo
```

```asm
; @launch grid=(256,1,1) block=(512,1,1) lds=163840
.amdgcn_target "amdgcn-amd-amdhsa--gfx950"
.text
.globl standalone__mha_block_cached__near_ridge_kernel
.p2align 8
.type standalone__mha_block_cached__near_ridge_kernel,@function
standalone__mha_block_cached__near_ridge_kernel:
  s_load_dwordx16 s[4:19], s[0:1], 0
  v_lshrrev_b32 v1, 6, v0
  s_cmp_ge_u32 s2, 256
  s_cbranch_scc1 L_end
  v_readfirstlane_b32 s20, v1
  s_bfe_u32 s51, s2, 0x20003
  s_and_b32 s21, s2, 1
  s_lshl2_add_u32 s21, s21, s51
  s_lshr_b32 s44, s2, 5
  s_bfe_u32 s22, s2, 0x20001
  s_lshl3_add_u32 s22, s22, s44
  s_mov_b32 s62, s20
  s_mov_b32 s63, 0x20000
  s_cmp_lt_u32 s20, 4
  s_cbranch_scc1 L_compute
  s_mul_i32 s51, s51, 5
  s_lshr_b32 s51, s51, 1
  s_add_u32 s23, s51, s44
  s_sub_u32 s51, s23, 10
  s_cmp_ge_u32 s23, 10
  s_cselect_b32 s23, s51, s23
  s_setprio 3
  s_sub_u32 s20, s20, 4
  v_and_b32 v1, 63, v0
  v_lshrrev_b32 v7, 4, v1
  v_and_b32 v8, 15, v1
  v_and_b32 v9, 7, v1
  v_xor_b32 v9, v9, v7
  v_lshlrev_b32 v9, 4, v9
  v_lshrrev_b32 v10, 3, v1
  v_mul_u32_u24 v10, 1280, v10
  s_mul_i32 s49, s20, 61440
  v_add3_u32 v12, v9, v10, s49
  v_xor_b32 v9, 64, v9
  v_add3_u32 v13, v9, v10, s49
  v_and_b32 v9, 1, v7
  v_lshlrev_b32 v9, 17, v9
  v_lshrrev_b32 v10, 1, v7
  v_lshl_add_u32 v9, v10, 15, v9
  v_lshl_add_u32 v9, v8, 4, v9
  s_and_b32 s49, s20, 1
  s_lshl_b32 s49, s49, 14
  s_lshr_b32 s50, s20, 1
  s_lshl_b32 s50, s50, 16
  s_add_u32 s49, s49, s50
  v_add_u32 v14, s49, v9
  s_mul_i32 s52, s20, 2112
  s_mul_i32 s57, s20, 6144
  s_mov_b32 s54, s23
  s_mov_b32 s45, 103424
  s_mul_i32 s49, s21, 245760
  s_lshl_b32 s50, s22, 8
  s_mov_b32 s26, 245760
  s_mov_b32 s27, 0x20000
  s_sub_u32 s34, 5242880, s50
  s_mov_b32 s35, 0x20000
  s_waitcnt lgkmcnt(0)
  s_add_u32 s32, s10, s50
  s_addc_u32 s33, s11, 0
  s_add_u32 s24, s4, s49
  s_addc_u32 s25, s5, 0
  s_lshl_b32 s50, s54, 19
  s_add_u32 s56, s45, s52
  s_add_u32 m0, s56, 24576
  s_add_u32 s53, s50, 0
  buffer_load_dwordx4 v14, s[32:35], s53 offen offset:0 lds
  s_add_u32 m0, s56, 25632
  s_add_u32 s53, s50, 8192
  buffer_load_dwordx4 v14, s[32:35], s53 offen offset:0 lds
  s_lshl_b32 s50, s54, 7
  s_add_u32 s56, s45, s57
  s_add_u32 m0, s56, 0
  s_add_u32 s53, s50, 0
  buffer_load_dwordx4 v12, s[24:27], s53 offen offset:0 lds
  s_add_u32 m0, s56, 1024
  s_add_u32 s53, s50, 10240
  buffer_load_dwordx4 v13, s[24:27], s53 offen offset:0 lds
  s_add_u32 m0, s56, 2048
  s_add_u32 s53, s50, 20480
  buffer_load_dwordx4 v12, s[24:27], s53 offen offset:0 lds
  s_add_u32 m0, s56, 3072
  s_add_u32 s53, s50, 30720
  buffer_load_dwordx4 v13, s[24:27], s53 offen offset:0 lds
  s_add_u32 m0, s56, 4096
  s_add_u32 s53, s50, 40960
  buffer_load_dwordx4 v12, s[24:27], s53 offen offset:0 lds
  s_add_u32 m0, s56, 5120
  s_add_u32 s53, s50, 51200
  buffer_load_dwordx4 v13, s[24:27], s53 offen offset:0 lds
  s_add_u32 s45, s45, 33792
  s_cmp_eq_u32 s45, 137216
  s_cselect_b32 s45, 35840, s45
  s_add_u32 s51, s52, 137216
  s_mov_b32 s46, s51
  s_mov_b32 s44, -2
  s_mov_b32 s47, 8
  s_mov_b32 s55, 0
  v_lshlrev_b32 v3, 9, v7
  v_lshl_add_u32 v3, v8, 2, v3
  s_lshl_b32 s49, s20, 6
  v_add_u32 v3, s49, v3
  v_and_b32 v4, 3, v1
  v_lshlrev_b32 v4, 9, v4
  v_mbcnt_lo_u32_b32 v254, -1, 0
  v_mbcnt_hi_u32_b32 v254, -1, v254
  v_lshlrev_b32 v252, 4, v254
  v_lshlrev_b32 v254, 2, v254
  s_waitcnt lgkmcnt(0)
L_w_go:
  s_lshl_b32 s50, s54, 19
  s_add_u32 m0, s46, 0
  s_add_u32 s53, s50, 262144
  s_waitcnt vmcnt(7)
  buffer_load_dwordx4 v14, s[32:35], s53 offen offset:0 lds
  s_add_u32 m0, s46, 1056
  s_add_u32 s53, s50, 270336
  s_waitcnt vmcnt(7)
  buffer_load_dwordx4 v14, s[32:35], s53 offen offset:0 lds
  s_add_u32 s46, s46, 8448
  s_cmp_ge_u32 s46, 162560
  s_cselect_b32 s46, s51, s46
  s_add_u32 s54, s54, 1
  s_cmp_eq_u32 s54, 10
  s_cselect_b32 s54, 0, s54
  s_cmp_eq_u32 s44, 7
  s_cbranch_scc1 L_w_done
  s_lshl_b32 s50, s54, 19
  s_add_u32 s56, s45, s52
  s_add_u32 m0, s56, 24576
  s_add_u32 s53, s50, 0
  s_waitcnt vmcnt(7)
  buffer_load_dwordx4 v14, s[32:35], s53 offen offset:0 lds
  s_add_u32 m0, s56, 25632
  s_add_u32 s53, s50, 8192
  s_waitcnt vmcnt(7)
  buffer_load_dwordx4 v14, s[32:35], s53 offen offset:0 lds
  s_lshl_b32 s50, s54, 7
  s_add_u32 s56, s45, s57
  s_add_u32 m0, s56, 0
  s_add_u32 s53, s50, 0
  s_waitcnt vmcnt(7)
  buffer_load_dwordx4 v12, s[24:27], s53 offen offset:0 lds
  s_add_u32 m0, s56, 1024
  s_add_u32 s53, s50, 10240
  s_waitcnt vmcnt(7)
  buffer_load_dwordx4 v13, s[24:27], s53 offen offset:0 lds
  s_add_u32 m0, s56, 2048
  s_add_u32 s53, s50, 20480
  s_waitcnt vmcnt(7)
  buffer_load_dwordx4 v12, s[24:27], s53 offen offset:0 lds
  s_add_u32 m0, s56, 3072
  s_add_u32 s53, s50, 30720
  s_waitcnt vmcnt(7)
  buffer_load_dwordx4 v13, s[24:27], s53 offen offset:0 lds
  s_add_u32 m0, s56, 4096
  s_add_u32 s53, s50, 40960
  s_waitcnt vmcnt(7)
  buffer_load_dwordx4 v12, s[24:27], s53 offen offset:0 lds
  s_add_u32 m0, s56, 5120
  s_add_u32 s53, s50, 51200
  s_waitcnt vmcnt(7)
  buffer_load_dwordx4 v13, s[24:27], s53 offen offset:0 lds
  s_add_u32 s45, s45, 33792
  s_cmp_eq_u32 s45, 137216
  s_cselect_b32 s45, 35840, s45
  s_add_u32 s44, s44, 1
  s_cmp_eq_u32 s44, 7
  s_cbranch_scc1 L_w_go
  s_waitcnt vmcnt(8)
  s_barrier
  s_branch L_w_go
L_w_done:
  s_lshl_b32 s50, s21, 5
  s_add_u32 s50, s50, s22
  s_lshl_b32 s50, s50, 19
  s_cmp_ge_u32 s20, 2
  s_cselect_b32 s28, s8, s6
  s_cselect_b32 s29, s9, s7
  s_cselect_b32 s56, 8448, 0
  s_add_u32 s28, s28, s50
  s_addc_u32 s29, s29, 0
  s_mov_b32 s30, 0x80000
  s_mov_b32 s31, 0x20000
  s_and_b32 s49, s20, 1
  s_mul_i32 s50, s49, 16896
  s_add_u32 s56, s56, s50
  s_lshl_b32 s53, s49, 13
  s_add_u32 m0, s56, 2048
  s_waitcnt vmcnt(7)
  buffer_load_dwordx4 v252, s[28:31], s53 offen offset:0 nt lds
  s_add_u32 m0, s56, 2080
  s_waitcnt vmcnt(7)
  buffer_load_dwordx4 v252, s[28:31], s53 offen offset:1024 nt lds
  s_add_u32 m0, s56, 2112
  s_waitcnt vmcnt(7)
  buffer_load_dwordx4 v252, s[28:31], s53 offen offset:2048 nt lds
  s_add_u32 m0, s56, 2144
  s_waitcnt vmcnt(7)
  buffer_load_dwordx4 v252, s[28:31], s53 offen offset:3072 nt lds
  s_add_u32 s53, s53, 4096
  s_barrier
  s_add_u32 m0, s56, 6272
  s_waitcnt vmcnt(7)
  buffer_load_dwordx4 v252, s[28:31], s53 offen offset:0 nt lds
  s_add_u32 m0, s56, 6304
  s_waitcnt vmcnt(7)
  buffer_load_dwordx4 v252, s[28:31], s53 offen offset:1024 nt lds
  s_add_u32 m0, s56, 6336
  s_waitcnt vmcnt(7)
  buffer_load_dwordx4 v252, s[28:31], s53 offen offset:2048 nt lds
  s_add_u32 m0, s56, 6368
  s_waitcnt vmcnt(7)
  buffer_load_dwordx4 v252, s[28:31], s53 offen offset:3072 nt lds
  s_mov_b32 s36, s18
  s_mov_b32 s37, s19
  s_mov_b32 s38, 33554432
  s_mov_b32 s39, 0x20000
  s_mov_b32 s40, s12
  s_mov_b32 s41, s13
  s_mov_b32 s42, 5242880
  s_mov_b32 s43, 0x20000
  s_mov_b32 s80, s14
  s_mov_b32 s81, s15
  s_mov_b32 s82, 1966080
  s_mov_b32 s83, 0x20000
  s_lshr_b32 s50, s2, 3
  s_mul_i32 s56, s50, 26
  s_lshr_b32 s56, s56, 8
  s_mul_i32 s57, s56, 10
  s_sub_u32 s57, s50, s57
  s_add_u32 s100, s57, s56
  s_lshl_b32 s57, s57, 7
  s_bfe_u32 s49, s2, 0x20001
  s_mul_i32 s49, s49, 3
  s_add_u32 s49, s49, s56
  s_and_b32 s50, s2, 1
  s_lshl1_add_u32 s49, s49, s50
  s_and_b32 s51, s62, 3
  s_lshl2_add_u32 s59, s49, s51
  s_mul_i32 s98, s59, 20480
  s_add_u32 s98, s98, s57
  s_lshl2_add_u32 s99, s50, s51
  s_lshl_b32 s99, s99, 2
  s_add_u32 s51, s51, 3
  s_and_b32 s51, s51, 3
  s_mul_i32 s84, s51, 33792
  s_add_u32 s84, s84, 2048
  s_add_u32 s85, s51, 29
  s_max_u32 s85, s85, 29
  s_lshl_b32 s85, s85, 5
  s_add_u32 s85, s85, 2064
  s_cmp_lt_u32 s62, 4
  s_cselect_b32 s50, 1, 0
  s_xor_b32 s49, s49, s50
  s_min_u32 s49, s49, 23
  s_mul_i32 s58, s49, 43
  s_lshr_b32 s58, s58, 7
  s_mul_i32 s59, s58, 3
  s_sub_u32 s59, s49, s59
  s_lshl2_add_u32 s49, s58, s59
  s_lshl_b32 s97, s49, 7
  s_add_u32 s97, s97, 25165824
  s_lshl_b32 s58, s58, 5
  s_lshl_b32 s59, s59, 12
  s_add_u32 s49, s100, 0
  s_and_b32 s49, s49, 3
  s_add_u32 s49, s49, s99
  s_add_u32 s50, s49, s58
  s_mul_i32 s92, s50, 49152
  s_add_u32 s92, s92, s59
  s_mul_i32 s88, s49, 163840
  s_add_u32 s88, s88, s57
  s_add_u32 s49, s100, 1
  s_and_b32 s49, s49, 3
  s_add_u32 s49, s49, s99
  s_add_u32 s50, s49, s58
  s_mul_i32 s93, s50, 49152
  s_add_u32 s93, s93, s59
  s_mul_i32 s89, s49, 163840
  s_add_u32 s89, s89, s57
  s_add_u32 s49, s100, 2
  s_and_b32 s49, s49, 3
  s_add_u32 s49, s49, s99
  s_add_u32 s50, s49, s58
  s_mul_i32 s94, s50, 49152
  s_add_u32 s94, s94, s59
  s_mul_i32 s90, s49, 163840
  s_add_u32 s90, s90, s57
  s_add_u32 s49, s100, 3
  s_and_b32 s49, s49, 3
  s_add_u32 s49, s49, s99
  s_add_u32 s50, s49, s58
  s_mul_i32 s95, s50, 49152
  s_add_u32 s95, s95, s59
  s_mul_i32 s91, s49, 163840
  s_add_u32 s91, s91, s57
  buffer_load_dword v251, v254, s[36:39], s97 offen offset:0 sc1
  s_cmp_ge_u32 s20, 1
  s_cbranch_scc1 L_wload
  s_lshl_b32 s50, s21, 5
  s_add_u32 s50, s50, s22
  s_lshl_b32 s50, s50, 19
  s_add_u32 s28, s6, s50
  s_addc_u32 s29, s7, 0
  s_mov_b32 s30, 0x80000
  s_mov_b32 s31, 0x20000
  s_add_u32 s76, s8, s50
  s_addc_u32 s77, s9, 0
  s_mov_b32 s78, 0x80000
  s_mov_b32 s79, 0x20000
  s_mov_b32 s52, 35840
  s_mov_b32 s53, 16384
  s_mov_b32 s46, 16384
  s_mov_b32 s44, 2
  s_mov_b32 s55, 0
  s_mov_b32 s56, 64
  s_mov_b32 s47, 0
  s_mov_b32 s51, 1
  s_mov_b32 s48, -1
  s_waitcnt vmcnt(9)
  s_barrier
  s_add_u32 m0, s52, 0
  s_nop 0
  buffer_load_dwordx4 v252, s[28:31], s53 offen offset:0 nt lds
  s_add_u32 m0, s52, 32
  s_nop 0
  buffer_load_dwordx4 v252, s[28:31], s53 offen offset:1024 nt lds
  s_add_u32 m0, s52, 64
  s_nop 0
  buffer_load_dwordx4 v252, s[28:31], s53 offen offset:2048 nt lds
  s_add_u32 m0, s52, 96
  s_nop 0
  buffer_load_dwordx4 v252, s[28:31], s53 offen offset:3072 nt lds
  s_add_u32 s53, s53, 4096
  s_add_u32 m0, s52, 4224
  s_nop 0
  buffer_load_dwordx4 v252, s[28:31], s53 offen offset:0 nt lds
  s_add_u32 m0, s52, 4256
  s_nop 0
  buffer_load_dwordx4 v252, s[28:31], s53 offen offset:1024 nt lds
  s_add_u32 m0, s52, 4288
  s_nop 0
  buffer_load_dwordx4 v252, s[28:31], s53 offen offset:2048 nt lds
  s_add_u32 m0, s52, 4320
  s_nop 0
  buffer_load_dwordx4 v252, s[28:31], s53 offen offset:3072 nt lds
  s_add_u32 s53, s53, 4096
  s_add_u32 m0, s52, 16896
  s_nop 0
  buffer_load_dwordx4 v252, s[28:31], s53 offen offset:0 nt lds
  s_add_u32 m0, s52, 16928
  s_nop 0
  buffer_load_dwordx4 v252, s[28:31], s53 offen offset:1024 nt lds
  s_add_u32 m0, s52, 16960
  s_nop 0
  buffer_load_dwordx4 v252, s[28:31], s53 offen offset:2048 nt lds
  s_add_u32 m0, s52, 16992
  s_nop 0
  buffer_load_dwordx4 v252, s[28:31], s53 offen offset:3072 nt lds
  s_add_u32 s53, s53, 4096
  s_barrier
  s_waitcnt vmcnt(12)
  s_max_i32 s55, s55, 130
  v_mov_b32 v5, s55
  ds_write_b32 v3, v5
  s_add_u32 m0, s52, 21120
  s_nop 0
  buffer_load_dwordx4 v252, s[28:31], s53 offen offset:0 nt lds
  s_waitcnt vmcnt(23)
  s_add_u32 m0, s52, 21152
  s_nop 0
  buffer_load_dwordx4 v252, s[28:31], s53 offen offset:1024 nt lds
  s_waitcnt vmcnt(23)
  s_add_u32 m0, s52, 21184
  s_nop 0
  buffer_load_dwordx4 v252, s[28:31], s53 offen offset:2048 nt lds
  s_waitcnt vmcnt(23)
  s_add_u32 m0, s52, 21216
  s_nop 0
  buffer_load_dwordx4 v252, s[28:31], s53 offen offset:3072 nt lds
  s_add_u32 s53, s53, 4096
  s_waitcnt vmcnt(23)
  s_add_u32 m0, s52, 8448
  s_nop 0
  buffer_load_dwordx4 v252, s[76:79], s46 offen offset:0 nt lds
  s_waitcnt vmcnt(23)
  s_add_u32 m0, s52, 8480
  s_nop 0
  buffer_load_dwordx4 v252, s[76:79], s46 offen offset:1024 nt lds
  s_waitcnt vmcnt(23)
  s_add_u32 m0, s52, 8512
  s_nop 0
  buffer_load_dwordx4 v252, s[76:79], s46 offen offset:2048 nt lds
  s_waitcnt vmcnt(23)
  s_add_u32 m0, s52, 8544
  s_nop 0
  buffer_load_dwordx4 v252, s[76:79], s46 offen offset:3072 nt lds
  s_add_u32 s46, s46, 4096
  s_waitcnt vmcnt(23)
  s_add_u32 m0, s52, 12672
  s_nop 0
  buffer_load_dwordx4 v252, s[76:79], s46 offen offset:0 nt lds
  s_waitcnt vmcnt(23)
  s_add_u32 m0, s52, 12704
  s_nop 0
  buffer_load_dwordx4 v252, s[76:79], s46 offen offset:1024 nt lds
  s_waitcnt vmcnt(23)
  s_add_u32 m0, s52, 12736
  s_nop 0
  buffer_load_dwordx4 v252, s[76:79], s46 offen offset:2048 nt lds
  s_waitcnt vmcnt(23)
  s_add_i32 s49, s44, 128
  s_max_i32 s55, s55, s49
  v_mov_b32 v5, s55
  ds_write_b32 v3, v5
  s_add_u32 m0, s52, 12768
  s_nop 0
  buffer_load_dwordx4 v252, s[76:79], s46 offen offset:3072 nt lds
  s_add_u32 s46, s46, 4096
  s_waitcnt vmcnt(23)
  s_add_u32 m0, s52, 25344
  s_nop 0
  buffer_load_dwordx4 v252, s[76:79], s46 offen offset:0 nt lds
  s_waitcnt vmcnt(23)
  s_add_u32 m0, s52, 25376
  s_nop 0
  buffer_load_dwordx4 v252, s[76:79], s46 offen offset:1024 nt lds
  s_waitcnt vmcnt(23)
  s_add_u32 m0, s52, 25408
  s_nop 0
  buffer_load_dwordx4 v252, s[76:79], s46 offen offset:2048 nt lds
  s_waitcnt vmcnt(23)
  s_add_u32 m0, s52, 25440
  s_nop 0
  buffer_load_dwordx4 v252, s[76:79], s46 offen offset:3072 nt lds
  s_add_u32 s46, s46, 4096
  s_waitcnt vmcnt(23)
  s_add_u32 m0, s52, 29568
  s_nop 0
  buffer_load_dwordx4 v252, s[76:79], s46 offen offset:0 nt lds
  s_waitcnt vmcnt(23)
  s_add_u32 m0, s52, 29600
  s_nop 0
  buffer_load_dwordx4 v252, s[76:79], s46 offen offset:1024 nt lds
  s_waitcnt vmcnt(23)
  s_add_u32 m0, s52, 29632
  s_nop 0
  buffer_load_dwordx4 v252, s[76:79], s46 offen offset:2048 nt lds
  s_waitcnt vmcnt(23)
  s_add_u32 m0, s52, 29664
  s_nop 0
  buffer_load_dwordx4 v252, s[76:79], s46 offen offset:3072 nt lds
  s_add_u32 s46, s46, 4096
  s_waitcnt vmcnt(23)
  s_branch L_kv_next
L_kv_loop:
  s_cmp_lt_u32 s44, 8
  s_cbranch_scc1 L_kv_go
  s_add_u32 s56, s44, 123
  s_lshl_b32 s56, s56, 4
L_kv_poll:
  ds_read_b32 v6, v4 offset:256
  s_waitcnt lgkmcnt(0)
  v_cmp_gt_u32 vcc, s56, v6
  s_nop 1
  s_cbranch_vccz L_kv_go2
  s_waitcnt vmcnt(0)
  s_add_u32 s49, s44, 128
  s_cmp_le_i32 s49, s55
  s_cbranch_scc1 L_kv_np
  s_max_i32 s55, s55, s49
  v_mov_b32 v5, s55
  ds_write_b32 v3, v5
L_kv_np:
  s_sleep 2
  s_sub_u32 s63, s63, 1
  s_cbranch_scc1 L_end
  s_branch L_kv_poll
L_kv_go:
  s_add_u32 m0, s52, 0
  s_nop 0
  buffer_load_dwordx4 v252, s[28:31], s53 offen offset:0 nt lds
  s_waitcnt vmcnt(23)
  s_add_u32 m0, s52, 32
  s_nop 0
  buffer_load_dwordx4 v252, s[28:31], s53 offen offset:1024 nt lds
  s_waitcnt vmcnt(23)
  s_add_u32 m0, s52, 64
  s_nop 0
  buffer_load_dwordx4 v252, s[28:31], s53 offen offset:2048 nt lds
  s_waitcnt vmcnt(23)
  s_add_u32 m0, s52, 96
  s_nop 0
  buffer_load_dwordx4 v252, s[28:31], s53 offen offset:3072 nt lds
  s_add_u32 s53, s53, 4096
  s_waitcnt vmcnt(23)
  s_add_u32 m0, s52, 4224
  s_nop 0
  buffer_load_dwordx4 v252, s[28:31], s53 offen offset:0 nt lds
  s_waitcnt vmcnt(23)
  s_add_u32 m0, s52, 4256
  s_nop 0
  buffer_load_dwordx4 v252, s[28:31], s53 offen offset:1024 nt lds
  s_waitcnt vmcnt(23)
  s_add_u32 m0, s52, 4288
  s_nop 0
  buffer_load_dwordx4 v252, s[28:31], s53 offen offset:2048 nt lds
  s_waitcnt vmcnt(23)
  s_add_i32 s49, s44, 127
  s_max_i32 s55, s55, s49
  v_mov_b32 v5, s55
  ds_write_b32 v3, v5
  s_add_u32 m0, s52, 4320
  s_nop 0
  buffer_load_dwordx4 v252, s[28:31], s53 offen offset:3072 nt lds
  s_add_u32 s53, s53, 4096
  s_waitcnt vmcnt(23)
  s_add_u32 m0, s52, 16896
  s_nop 0
  buffer_load_dwordx4 v252, s[28:31], s53 offen offset:0 nt lds
  s_waitcnt vmcnt(23)
  s_add_u32 m0, s52, 16928
  s_nop 0
  buffer_load_dwordx4 v252, s[28:31], s53 offen offset:1024 nt lds
  s_waitcnt vmcnt(23)
  s_add_u32 m0, s52, 16960
  s_nop 0
  buffer_load_dwordx4 v252, s[28:31], s53 offen offset:2048 nt lds
  s_waitcnt vmcnt(23)
  s_add_u32 m0, s52, 16992
  s_nop 0
  buffer_load_dwordx4 v252, s[28:31], s53 offen offset:3072 nt lds
  s_add_u32 s53, s53, 4096
  s_waitcnt vmcnt(23)
  s_add_u32 m0, s52, 21120
  s_nop 0
  buffer_load_dwordx4 v252, s[28:31], s53 offen offset:0 nt lds
  s_waitcnt vmcnt(23)
  s_add_u32 m0, s52, 21152
  s_nop 0
  buffer_load_dwordx4 v252, s[28:31], s53 offen offset:1024 nt lds
  s_waitcnt vmcnt(23)
  s_add_u32 m0, s52, 21184
  s_nop 0
  buffer_load_dwordx4 v252, s[28:31], s53 offen offset:2048 nt lds
  s_waitcnt vmcnt(23)
  s_add_u32 m0, s52, 21216
  s_nop 0
  buffer_load_dwordx4 v252, s[28:31], s53 offen offset:3072 nt lds
  s_add_u32 s53, s53, 4096
  s_waitcnt vmcnt(23)
  s_add_u32 m0, s52, 8448
  s_nop 0
  buffer_load_dwordx4 v252, s[76:79], s46 offen offset:0 nt lds
  s_waitcnt vmcnt(23)
  s_add_u32 m0, s52, 8480
  s_nop 0
  buffer_load_dwordx4 v252, s[76:79], s46 offen offset:1024 nt lds
  s_waitcnt vmcnt(23)
  s_add_u32 m0, s52, 8512
  s_nop 0
  buffer_load_dwordx4 v252, s[76:79], s46 offen offset:2048 nt lds
  s_waitcnt vmcnt(23)
  s_add_u32 m0, s52, 8544
  s_nop 0
  buffer_load_dwordx4 v252, s[76:79], s46 offen offset:3072 nt lds
  s_add_u32 s46, s46, 4096
  s_waitcnt vmcnt(23)
  s_add_u32 m0, s52, 12672
  s_nop 0
  buffer_load_dwordx4 v252, s[76:79], s46 offen offset:0 nt lds
  s_waitcnt vmcnt(23)
  s_add_u32 m0, s52, 12704
  s_nop 0
  buffer_load_dwordx4 v252, s[76:79], s46 offen offset:1024 nt lds
  s_waitcnt vmcnt(23)
  s_add_u32 m0, s52, 12736
  s_nop 0
  buffer_load_dwordx4 v252, s[76:79], s46 offen offset:2048 nt lds
  s_waitcnt vmcnt(23)
  s_add_i32 s49, s44, 128
  s_max_i32 s55, s55, s49
  v_mov_b32 v5, s55
  ds_write_b32 v3, v5
  s_add_u32 m0, s52, 12768
  s_nop 0
  buffer_load_dwordx4 v252, s[76:79], s46 offen offset:3072 nt lds
  s_add_u32 s46, s46, 4096
  s_waitcnt vmcnt(23)
  s_add_u32 m0, s52, 25344
  s_nop 0
  buffer_load_dwordx4 v252, s[76:79], s46 offen offset:0 nt lds
  s_waitcnt vmcnt(23)
  s_add_u32 m0, s52, 25376
  s_nop 0
  buffer_load_dwordx4 v252, s[76:79], s46 offen offset:1024 nt lds
  s_waitcnt vmcnt(23)
  s_add_u32 m0, s52, 25408
  s_nop 0
  buffer_load_dwordx4 v252, s[76:79], s46 offen offset:2048 nt lds
  s_waitcnt vmcnt(23)
  s_add_u32 m0, s52, 25440
  s_nop 0
  buffer_load_dwordx4 v252, s[76:79], s46 offen offset:3072 nt lds
  s_add_u32 s46, s46, 4096
  s_waitcnt vmcnt(23)
  s_add_u32 m0, s52, 29568
  s_nop 0
  buffer_load_dwordx4 v252, s[76:79], s46 offen offset:0 nt lds
  s_waitcnt vmcnt(23)
  s_add_u32 m0, s52, 29600
  s_nop 0
  buffer_load_dwordx4 v252, s[76:79], s46 offen offset:1024 nt lds
  s_waitcnt vmcnt(23)
  s_add_u32 m0, s52, 29632
  s_nop 0
  buffer_load_dwordx4 v252, s[76:79], s46 offen offset:2048 nt lds
  s_waitcnt vmcnt(23)
  s_add_u32 m0, s52, 29664
  s_nop 0
  buffer_load_dwordx4 v252, s[76:79], s46 offen offset:3072 nt lds
  s_add_u32 s46, s46, 4096
  s_waitcnt vmcnt(23)
  s_branch L_kv_next
L_kv_go2:
  s_cmp_lg_u32 s47, 0
  s_cbranch_scc1 L_kv_sel
  s_add_u32 m0, s52, 0
  s_nop 0
  buffer_load_dwordx4 v252, s[28:31], s53 offen offset:0 nt lds
  s_waitcnt vmcnt(16)
  s_add_i32 s49, s44, 127
  s_cmp_le_i32 s49, s55
  s_cbranch_scc1 L_kv_np2_17
  s_max_i32 s55, s55, s49
  v_mov_b32 v5, s55
  ds_write_b32 v3, v5
L_kv_np2_17:
  s_add_u32 m0, s52, 32
  s_nop 0
  buffer_load_dwordx4 v252, s[28:31], s53 offen offset:1024 nt lds
  v_and_b32 v7, 15, v6
  v_cmp_gt_u32 vcc, 9, v7
  s_sub_u32 s47, s47, 1
  s_max_i32 s50, s48, 0
  s_max_i32 s47, s47, s50
  s_or_b32 s49, vcc_lo, s51
  s_mov_b32 s51, vcc_lo
  s_cbranch_scc1 L_kv_ok17
  s_cmp_lt_i32 s47, 4
  s_cselect_b32 s50, 2, 0
  s_add_i32 s48, s48, s50
  s_mov_b32 s47, 6
L_kv_ok17:
  s_waitcnt vmcnt(16)
  s_add_u32 m0, s52, 64
  s_nop 0
  buffer_load_dwordx4 v252, s[28:31], s53 offen offset:2048 nt lds
  s_waitcnt vmcnt(16)
  s_add_u32 m0, s52, 96
  s_nop 0
  buffer_load_dwordx4 v252, s[28:31], s53 offen offset:3072 nt lds
  s_add_u32 s53, s53, 4096
  s_waitcnt vmcnt(16)
  s_add_u32 m0, s52, 4224
  s_nop 0
  buffer_load_dwordx4 v252, s[28:31], s53 offen offset:0 nt lds
  s_waitcnt vmcnt(16)
  s_add_u32 m0, s52, 4256
  s_nop 0
  buffer_load_dwordx4 v252, s[28:31], s53 offen offset:1024 nt lds
  s_waitcnt vmcnt(16)
  s_add_u32 m0, s52, 4288
  s_nop 0
  buffer_load_dwordx4 v252, s[28:31], s53 offen offset:2048 nt lds
  s_waitcnt vmcnt(16)
  s_add_u32 m0, s52, 4320
  s_nop 0
  buffer_load_dwordx4 v252, s[28:31], s53 offen offset:3072 nt lds
  s_add_u32 s53, s53, 4096
  s_waitcnt vmcnt(16)
  s_add_u32 m0, s52, 16896
  s_nop 0
  buffer_load_dwordx4 v252, s[28:31], s53 offen offset:0 nt lds
  s_waitcnt vmcnt(16)
  s_add_u32 m0, s52, 16928
  s_nop 0
  buffer_load_dwordx4 v252, s[28:31], s53 offen offset:1024 nt lds
  s_waitcnt vmcnt(16)
  s_add_u32 m0, s52, 16960
  s_nop 0
  buffer_load_dwordx4 v252, s[28:31], s53 offen offset:2048 nt lds
  s_waitcnt vmcnt(16)
  s_add_u32 m0, s52, 16992
  s_nop 0
  buffer_load_dwordx4 v252, s[28:31], s53 offen offset:3072 nt lds
  s_add_u32 s53, s53, 4096
  s_waitcnt vmcnt(16)
  s_add_u32 m0, s52, 21120
  s_nop 0
  buffer_load_dwordx4 v252, s[28:31], s53 offen offset:0 nt lds
  s_waitcnt vmcnt(16)
  s_add_u32 m0, s52, 21152
  s_nop 0
  buffer_load_dwordx4 v252, s[28:31], s53 offen offset:1024 nt lds
  s_waitcnt vmcnt(16)
  s_add_u32 m0, s52, 21184
  s_nop 0
  buffer_load_dwordx4 v252, s[28:31], s53 offen offset:2048 nt lds
  s_waitcnt vmcnt(16)
  s_add_u32 m0, s52, 21216
  s_nop 0
  buffer_load_dwordx4 v252, s[28:31], s53 offen offset:3072 nt lds
  s_add_u32 s53, s53, 4096
  s_waitcnt vmcnt(16)
  s_add_i32 s49, s44, 128
  s_max_i32 s55, s55, s49
  v_mov_b32 v5, s55
  ds_write_b32 v3, v5
  s_add_u32 m0, s52, 8448
  s_nop 0
  buffer_load_dwordx4 v252, s[76:79], s46 offen offset:0 nt lds
  s_waitcnt vmcnt(16)
  s_add_u32 m0, s52, 8480
  s_nop 0
  buffer_load_dwordx4 v252, s[76:79], s46 offen offset:1024 nt lds
  s_waitcnt vmcnt(16)
  s_add_u32 m0, s52, 8512
  s_nop 0
  buffer_load_dwordx4 v252, s[76:79], s46 offen offset:2048 nt lds
  s_waitcnt vmcnt(16)
  s_add_u32 m0, s52, 8544
  s_nop 0
  buffer_load_dwordx4 v252, s[76:79], s46 offen offset:3072 nt lds
  s_add_u32 s46, s46, 4096
  s_waitcnt vmcnt(16)
  s_add_u32 m0, s52, 12672
  s_nop 0
  buffer_load_dwordx4 v252, s[76:79], s46 offen offset:0 nt lds
  s_waitcnt vmcnt(16)
  s_add_u32 m0, s52, 12704
  s_nop 0
  buffer_load_dwordx4 v252, s[76:79], s46 offen offset:1024 nt lds
  s_waitcnt vmcnt(16)
  s_add_u32 m0, s52, 12736
  s_nop 0
  buffer_load_dwordx4 v252, s[76:79], s46 offen offset:2048 nt lds
  s_waitcnt vmcnt(16)
  s_add_u32 m0, s52, 12768
  s_nop 0
  buffer_load_dwordx4 v252, s[76:79], s46 offen offset:3072 nt lds
  s_add_u32 s46, s46, 4096
  s_waitcnt vmcnt(16)
  s_add_u32 m0, s52, 25344
  s_nop 0
  buffer_load_dwordx4 v252, s[76:79], s46 offen offset:0 nt lds
  s_waitcnt vmcnt(16)
  s_add_u32 m0, s52, 25376
  s_nop 0
  buffer_load_dwordx4 v252, s[76:79], s46 offen offset:1024 nt lds
  s_waitcnt vmcnt(16)
  s_add_u32 m0, s52, 25408
  s_nop 0
  buffer_load_dwordx4 v252, s[76:79], s46 offen offset:2048 nt lds
  s_waitcnt vmcnt(16)
  s_add_u32 m0, s52, 25440
  s_nop 0
  buffer_load_dwordx4 v252, s[76:79], s46 offen offset:3072 nt lds
  s_add_u32 s46, s46, 4096
  s_waitcnt vmcnt(16)
  s_add_u32 m0, s52, 29568
  s_nop 0
  buffer_load_dwordx4 v252, s[76:79], s46 offen offset:0 nt lds
  s_waitcnt vmcnt(16)
  s_add_u32 m0, s52, 29600
  s_nop 0
  buffer_load_dwordx4 v252, s[76:79], s46 offen offset:1024 nt lds
  s_waitcnt vmcnt(16)
  s_add_u32 m0, s52, 29632
  s_nop 0
  buffer_load_dwordx4 v252, s[76:79], s46 offen offset:2048 nt lds
  s_waitcnt vmcnt(16)
  s_add_u32 m0, s52, 29664
  s_nop 0
  buffer_load_dwordx4 v252, s[76:79], s46 offen offset:3072 nt lds
  s_add_u32 s46, s46, 4096
  s_waitcnt vmcnt(16)
  s_add_i32 s49, s44, 129
  s_max_i32 s55, s55, s49
  v_mov_b32 v5, s55
  ds_write_b32 v3, v5
L_kv_meas:
L_kv_next:
  s_add_u32 s44, s44, 2
  s_add_u32 s52, s52, 33792
  s_and_b32 s49, s44, 7
  s_cselect_b32 s52, s52, 2048
  s_cmp_lt_u32 s44, 64
  s_cbranch_scc1 L_kv_loop
  s_waitcnt vmcnt(32)
  s_max_i32 s55, s55, 190
  v_mov_b32 v5, s55
  ds_write_b32 v3, v5
  s_waitcnt vmcnt(16)
  s_max_i32 s55, s55, 191
  v_mov_b32 v5, s55
  ds_write_b32 v3, v5
  s_waitcnt vmcnt(0)
  s_max_i32 s55, s55, 32768
  v_mov_b32 v5, s55
  ds_write_b32 v3, v5
  s_setprio 0
  s_cmp_ge_u32 s2, 240
  s_cbranch_scc1 L_end
  v_lshrrev_b32 v248, 5, v254
  v_mul_u32_u24 v248, 5120, v248
  v_and_b32 v249, 0x70, v252
  v_add_u32 v253, v248, v249
  v_bfe_u32 v248, v254, 4, 2
  v_mul_u32_u24 v248, 1056, v248
  v_lshrrev_b32 v249, 6, v254
  v_lshl_add_u32 v248, v249, 7, v248
  v_and_b32 v249, 12, v254
  v_lshlrev_b32 v245, 7, v249
  v_lshl_add_u32 v248, v249, 1, v248
  v_add_u32 v250, s84, v248
  s_mov_b32 s87, 137216
  v_add_u32 v244, s87, v248
  s_add_u32 s49, s88, 0
  s_add_u32 m0, s87, 0
  s_nop 0
  buffer_load_dwordx4 v253, s[40:43], s49 offen offset:0 lds
  s_add_u32 m0, s87, -224
  s_nop 0
  buffer_load_dwordx4 v253, s[40:43], s49 offen offset:1280 lds
  s_add_u32 m0, s87, -448
  s_nop 0
  buffer_load_dwordx4 v253, s[40:43], s49 offen offset:2560 lds
  s_add_u32 m0, s87, -672
  s_nop 0
  buffer_load_dwordx4 v253, s[40:43], s49 offen offset:3840 lds
  s_add_u32 s49, s88, 40960
  s_add_u32 m0, s87, 4224
  s_nop 0
  buffer_load_dwordx4 v253, s[40:43], s49 offen offset:0 lds
  s_add_u32 m0, s87, 4000
  s_nop 0
  buffer_load_dwordx4 v253, s[40:43], s49 offen offset:1280 lds
  s_add_u32 m0, s87, 3776
  s_nop 0
  buffer_load_dwordx4 v253, s[40:43], s49 offen offset:2560 lds
  s_add_u32 m0, s87, 3552
  s_nop 0
  buffer_load_dwordx4 v253, s[40:43], s49 offen offset:3840 lds
  s_add_u32 s49, s88, 81920
  s_add_u32 m0, s87, 8448
  s_nop 0
  buffer_load_dwordx4 v253, s[40:43], s49 offen offset:0 lds
  s_add_u32 m0, s87, 8224
  s_nop 0
  buffer_load_dwordx4 v253, s[40:43], s49 offen offset:1280 lds
  s_add_u32 m0, s87, 8000
  s_nop 0
  buffer_load_dwordx4 v253, s[40:43], s49 offen offset:2560 lds
  s_add_u32 m0, s87, 7776
  s_nop 0
  buffer_load_dwordx4 v253, s[40:43], s49 offen offset:3840 lds
  s_add_u32 s49, s88, 122880
  s_add_u32 m0, s87, 12672
  s_nop 0
  buffer_load_dwordx4 v253, s[40:43], s49 offen offset:0 lds
  s_add_u32 m0, s87, 12448
  s_nop 0
  buffer_load_dwordx4 v253, s[40:43], s49 offen offset:1280 lds
  s_add_u32 m0, s87, 12224
  s_nop 0
  buffer_load_dwordx4 v253, s[40:43], s49 offen offset:2560 lds
  s_add_u32 m0, s87, 12000
  s_nop 0
  buffer_load_dwordx4 v253, s[40:43], s49 offen offset:3840 lds
  s_add_u32 s49, s89, 0
  s_add_u32 m0, s87, 16896
  s_nop 0
  buffer_load_dwordx4 v253, s[40:43], s49 offen offset:0 lds
  s_add_u32 m0, s87, 16672
  s_nop 0
  buffer_load_dwordx4 v253, s[40:43], s49 offen offset:1280 lds
  s_add_u32 m0, s87, 16448
  s_nop 0
  buffer_load_dwordx4 v253, s[40:43], s49 offen offset:2560 lds
  s_add_u32 m0, s87, 16224
  s_nop 0
  buffer_load_dwordx4 v253, s[40:43], s49 offen offset:3840 lds
  s_add_u32 s49, s89, 40960
  s_add_u32 m0, s87, 21120
  s_nop 0
  buffer_load_dwordx4 v253, s[40:43], s49 offen offset:0 lds
  s_add_u32 m0, s87, 20896
  s_nop 0
  buffer_load_dwordx4 v253, s[40:43], s49 offen offset:1280 lds
  s_add_u32 m0, s87, 20672
  s_nop 0
  buffer_load_dwordx4 v253, s[40:43], s49 offen offset:2560 lds
  s_add_u32 m0, s87, 20448
  s_nop 0
  buffer_load_dwordx4 v253, s[40:43], s49 offen offset:3840 lds
L_h0rg:
  s_sub_u32 s63, s63, 1
  s_cbranch_scc1 L_end
  ds_read_b32 v6, v4 offset:256
  s_waitcnt lgkmcnt(0)
  v_cmp_gt_u32 vcc, 3088, v6
  s_nop 1
  s_cbranch_vccz L_h0rg_d
  s_sleep 2
  s_branch L_h0rg
L_h0rg_d:
  s_add_u32 s49, s89, 81920
  s_add_u32 m0, s84, 25344
  s_nop 0
  buffer_load_dwordx4 v253, s[40:43], s49 offen offset:0 lds
  s_add_u32 m0, s84, 25120
  s_nop 0
  buffer_load_dwordx4 v253, s[40:43], s49 offen offset:1280 lds
  s_add_u32 m0, s84, 24896
  s_nop 0
  buffer_load_dwordx4 v253, s[40:43], s49 offen offset:2560 lds
  s_add_u32 m0, s84, 24672
  s_nop 0
  buffer_load_dwordx4 v253, s[40:43], s49 offen offset:3840 lds
  s_add_u32 s49, s89, 122880
  s_add_u32 m0, s84, 29568
  s_nop 0
  buffer_load_dwordx4 v253, s[40:43], s49 offen offset:0 lds
  s_add_u32 m0, s84, 29344
  s_nop 0
  buffer_load_dwordx4 v253, s[40:43], s49 offen offset:1280 lds
  s_add_u32 m0, s84, 29120
  s_nop 0
  buffer_load_dwordx4 v253, s[40:43], s49 offen offset:2560 lds
  s_add_u32 m0, s84, 28896
  s_nop 0
  buffer_load_dwordx4 v253, s[40:43], s49 offen offset:3840 lds
  s_waitcnt vmcnt(28)
  ds_read_b64_tr_b16 v[64:65], v244 offset:0
  ds_read_b64_tr_b16 v[66:67], v244 offset:512
  ds_read_b64_tr_b16 v[68:69], v244 offset:32
  ds_read_b64_tr_b16 v[70:71], v244 offset:544
  ds_read_b64_tr_b16 v[72:73], v244 offset:64
  ds_read_b64_tr_b16 v[74:75], v244 offset:576
  ds_read_b64_tr_b16 v[76:77], v244 offset:96
  ds_read_b64_tr_b16 v[78:79], v244 offset:608
  s_add_u32 s49, s90, 0
  s_add_u32 m0, s84, 0
  s_nop 0
  buffer_load_dwordx4 v253, s[40:43], s49 offen offset:0 lds
  s_add_u32 m0, s84, -224
  s_nop 0
  buffer_load_dwordx4 v253, s[40:43], s49 offen offset:1280 lds
  s_add_u32 m0, s84, -448
  s_nop 0
  buffer_load_dwordx4 v253, s[40:43], s49 offen offset:2560 lds
  s_add_u32 m0, s84, -672
  s_nop 0
  buffer_load_dwordx4 v253, s[40:43], s49 offen offset:3840 lds
  s_waitcnt vmcnt(28)
  ds_read_b64_tr_b16 v[80:81], v244 offset:4224
  ds_read_b64_tr_b16 v[82:83], v244 offset:4736
  ds_read_b64_tr_b16 v[84:85], v244 offset:4256
  ds_read_b64_tr_b16 v[86:87], v244 offset:4768
  ds_read_b64_tr_b16 v[88:89], v244 offset:4288
  ds_read_b64_tr_b16 v[90:91], v244 offset:4800
  ds_read_b64_tr_b16 v[92:93], v244 offset:4320
  ds_read_b64_tr_b16 v[94:95], v244 offset:4832
  s_add_u32 s49, s90, 40960
  s_add_u32 m0, s84, 4224
  s_nop 0
  buffer_load_dwordx4 v253, s[40:43], s49 offen offset:0 lds
  s_add_u32 m0, s84, 4000
  s_nop 0
  buffer_load_dwordx4 v253, s[40:43], s49 offen offset:1280 lds
  s_add_u32 m0, s84, 3776
  s_nop 0
  buffer_load_dwordx4 v253, s[40:43], s49 offen offset:2560 lds
  s_add_u32 m0, s84, 3552
  s_nop 0
  buffer_load_dwordx4 v253, s[40:43], s49 offen offset:3840 lds
  s_waitcnt vmcnt(28)
  ds_read_b64_tr_b16 v[96:97], v244 offset:8448
  ds_read_b64_tr_b16 v[98:99], v244 offset:8960
  ds_read_b64_tr_b16 v[100:101], v244 offset:8480
  ds_read_b64_tr_b16 v[102:103], v244 offset:8992
  ds_read_b64_tr_b16 v[104:105], v244 offset:8512
  ds_read_b64_tr_b16 v[106:107], v244 offset:9024
  ds_read_b64_tr_b16 v[108:109], v244 offset:8544
  ds_read_b64_tr_b16 v[110:111], v244 offset:9056
  s_add_u32 s49, s90, 81920
  s_add_u32 m0, s84, 8448
  s_nop 0
  buffer_load_dwordx4 v253, s[40:43], s49 offen offset:0 lds
  s_add_u32 m0, s84, 8224
  s_nop 0
  buffer_load_dwordx4 v253, s[40:43], s49 offen offset:1280 lds
  s_add_u32 m0, s84, 8000
  s_nop 0
  buffer_load_dwordx4 v253, s[40:43], s49 offen offset:2560 lds
  s_add_u32 m0, s84, 7776
  s_nop 0
  buffer_load_dwordx4 v253, s[40:43], s49 offen offset:3840 lds
  s_waitcnt vmcnt(28)
  ds_read_b64_tr_b16 v[112:113], v244 offset:12672
  ds_read_b64_tr_b16 v[114:115], v244 offset:13184
  ds_read_b64_tr_b16 v[116:117], v244 offset:12704
  ds_read_b64_tr_b16 v[118:119], v244 offset:13216
  ds_read_b64_tr_b16 v[120:121], v244 offset:12736
  ds_read_b64_tr_b16 v[122:123], v244 offset:13248
  ds_read_b64_tr_b16 v[124:125], v244 offset:12768
  ds_read_b64_tr_b16 v[126:127], v244 offset:13280
  s_add_u32 s49, s90, 122880
  s_add_u32 m0, s84, 12672
  s_nop 0
  buffer_load_dwordx4 v253, s[40:43], s49 offen offset:0 lds
  s_add_u32 m0, s84, 12448
  s_nop 0
  buffer_load_dwordx4 v253, s[40:43], s49 offen offset:1280 lds
  s_add_u32 m0, s84, 12224
  s_nop 0
  buffer_load_dwordx4 v253, s[40:43], s49 offen offset:2560 lds
  s_add_u32 m0, s84, 12000
  s_nop 0
  buffer_load_dwordx4 v253, s[40:43], s49 offen offset:3840 lds
  s_waitcnt vmcnt(28)
  ds_read_b64_tr_b16 v[128:129], v244 offset:16896
  ds_read_b64_tr_b16 v[130:131], v244 offset:17408
  ds_read_b64_tr_b16 v[132:133], v244 offset:16928
  ds_read_b64_tr_b16 v[134:135], v244 offset:17440
  ds_read_b64_tr_b16 v[136:137], v244 offset:16960
  ds_read_b64_tr_b16 v[138:139], v244 offset:17472
  ds_read_b64_tr_b16 v[140:141], v244 offset:16992
  ds_read_b64_tr_b16 v[142:143], v244 offset:17504
  s_add_u32 s49, s91, 0
  s_add_u32 m0, s84, 16896
  s_nop 0
  buffer_load_dwordx4 v253, s[40:43], s49 offen offset:0 lds
  s_add_u32 m0, s84, 16672
  s_nop 0
  buffer_load_dwordx4 v253, s[40:43], s49 offen offset:1280 lds
  s_add_u32 m0, s84, 16448
  s_nop 0
  buffer_load_dwordx4 v253, s[40:43], s49 offen offset:2560 lds
  s_add_u32 m0, s84, 16224
  s_nop 0
  buffer_load_dwordx4 v253, s[40:43], s49 offen offset:3840 lds
  s_waitcnt vmcnt(28)
  ds_read_b64_tr_b16 v[144:145], v244 offset:21120
  ds_read_b64_tr_b16 v[146:147], v244 offset:21632
  ds_read_b64_tr_b16 v[148:149], v244 offset:21152
  ds_read_b64_tr_b16 v[150:151], v244 offset:21664
  ds_read_b64_tr_b16 v[152:153], v244 offset:21184
  ds_read_b64_tr_b16 v[154:155], v244 offset:21696
  ds_read_b64_tr_b16 v[156:157], v244 offset:21216
  ds_read_b64_tr_b16 v[158:159], v244 offset:21728
  s_add_u32 s49, s91, 40960
  s_add_u32 m0, s84, 21120
  s_nop 0
  buffer_load_dwordx4 v253, s[40:43], s49 offen offset:0 lds
  s_add_u32 m0, s84, 20896
  s_nop 0
  buffer_load_dwordx4 v253, s[40:43], s49 offen offset:1280 lds
  s_add_u32 m0, s84, 20672
  s_nop 0
  buffer_load_dwordx4 v253, s[40:43], s49 offen offset:2560 lds
  s_add_u32 m0, s84, 20448
  s_nop 0
  buffer_load_dwordx4 v253, s[40:43], s49 offen offset:3840 lds
  s_waitcnt vmcnt(28)
  ds_read_b64_tr_b16 v[160:161], v250 offset:25344
  ds_read_b64_tr_b16 v[162:163], v250 offset:25856
  ds_read_b64_tr_b16 v[164:165], v250 offset:25376
  ds_read_b64_tr_b16 v[166:167], v250 offset:25888
  ds_read_b64_tr_b16 v[168:169], v250 offset:25408
  ds_read_b64_tr_b16 v[170:171], v250 offset:25920
  ds_read_b64_tr_b16 v[172:173], v250 offset:25440
  ds_read_b64_tr_b16 v[174:175], v250 offset:25952
  s_waitcnt vmcnt(24)
  ds_read_b64_tr_b16 v[176:177], v250 offset:29568
  ds_read_b64_tr_b16 v[178:179], v250 offset:30080
  ds_read_b64_tr_b16 v[180:181], v250 offset:29600
  ds_read_b64_tr_b16 v[182:183], v250 offset:30112
  ds_read_b64_tr_b16 v[184:185], v250 offset:29632
  ds_read_b64_tr_b16 v[186:187], v250 offset:30144
  ds_read_b64_tr_b16 v[188:189], v250 offset:29664
  ds_read_b64_tr_b16 v[190:191], v250 offset:30176
  s_max_i32 s55, s55, 32769
  v_mov_b32 v5, s55
  ds_write_b32 v3, v5
  s_waitcnt lgkmcnt(0)
  s_waitcnt vmcnt(0)
  s_branch L_tail3
L_wload:
  s_waitcnt vmcnt(9)
  s_barrier
  s_barrier
  s_waitcnt vmcnt(0)
  s_max_i32 s55, s55, 32767
  v_mov_b32 v5, s55
  ds_write_b32 v3, v5
  s_setprio 0
  s_cmp_ge_u32 s2, 240
  s_cbranch_scc1 L_end
L_h_w:
  s_sub_u32 s63, s63, 1
  s_cbranch_scc1 L_end
  s_sleep 16
  ds_read_b32 v6, v4 offset:0
  s_waitcnt lgkmcnt(0)
  v_cmp_gt_u32 vcc, 184, v6
  s_nop 1
  s_cbranch_vccnz L_h_w
L_h_w2:
  s_sub_u32 s63, s63, 1
  s_cbranch_scc1 L_end
  s_sleep 2
  ds_read_b32 v6, v4 offset:0
  s_waitcnt lgkmcnt(0)
  v_cmp_gt_u32 vcc, 191, v6
  s_nop 1
  s_cbranch_vccnz L_h_w2
L_hstage:
  v_lshrrev_b32 v248, 5, v254
  v_mul_u32_u24 v248, 5120, v248
  v_and_b32 v249, 0x70, v252
  v_add_u32 v253, v248, v249
  v_bfe_u32 v248, v254, 4, 2
  v_mul_u32_u24 v248, 1056, v248
  v_lshrrev_b32 v249, 6, v254
  v_lshl_add_u32 v248, v249, 7, v248
  v_and_b32 v249, 12, v254
  v_lshlrev_b32 v245, 7, v249
  v_lshl_add_u32 v248, v249, 1, v248
  v_add_u32 v250, s84, v248
L_hrg:
  s_sub_u32 s63, s63, 1
  s_cbranch_scc1 L_end
  ds_read_b32 v6, v4 offset:256
  s_waitcnt lgkmcnt(0)
  v_cmp_gt_u32 vcc, s85, v6
  s_nop 1
  s_cbranch_vccz L_hrg_d
  s_sleep 2
  s_branch L_hrg
L_hrg_d:
  s_add_u32 s49, s88, 0
  s_add_u32 m0, s84, 0
  s_nop 0
  buffer_load_dwordx4 v253, s[40:43], s49 offen offset:0 lds
  s_add_u32 m0, s84, -224
  s_nop 0
  buffer_load_dwordx4 v253, s[40:43], s49 offen offset:1280 lds
  s_add_u32 m0, s84, -448
  s_nop 0
  buffer_load_dwordx4 v253, s[40:43], s49 offen offset:2560 lds
  s_add_u32 m0, s84, -672
  s_nop 0
  buffer_load_dwordx4 v253, s[40:43], s49 offen offset:3840 lds
  s_add_u32 s49, s88, 40960
  s_add_u32 m0, s84, 4224
  s_nop 0
  buffer_load_dwordx4 v253, s[40:43], s49 offen offset:0 lds
  s_add_u32 m0, s84, 4000
  s_nop 0
  buffer_load_dwordx4 v253, s[40:43], s49 offen offset:1280 lds
  s_add_u32 m0, s84, 3776
  s_nop 0
  buffer_load_dwordx4 v253, s[40:43], s49 offen offset:2560 lds
  s_add_u32 m0, s84, 3552
  s_nop 0
  buffer_load_dwordx4 v253, s[40:43], s49 offen offset:3840 lds
  s_add_u32 s49, s88, 81920
  s_add_u32 m0, s84, 8448
  s_nop 0
  buffer_load_dwordx4 v253, s[40:43], s49 offen offset:0 lds
  s_add_u32 m0, s84, 8224
  s_nop 0
  buffer_load_dwordx4 v253, s[40:43], s49 offen offset:1280 lds
  s_add_u32 m0, s84, 8000
  s_nop 0
  buffer_load_dwordx4 v253, s[40:43], s49 offen offset:2560 lds
  s_add_u32 m0, s84, 7776
  s_nop 0
  buffer_load_dwordx4 v253, s[40:43], s49 offen offset:3840 lds
  s_waitcnt vmcnt(8)
  ds_read_b64_tr_b16 v[64:65], v250 offset:0
  ds_read_b64_tr_b16 v[66:67], v250 offset:512
  ds_read_b64_tr_b16 v[68:69], v250 offset:32
  ds_read_b64_tr_b16 v[70:71], v250 offset:544
  ds_read_b64_tr_b16 v[72:73], v250 offset:64
  ds_read_b64_tr_b16 v[74:75], v250 offset:576
  ds_read_b64_tr_b16 v[76:77], v250 offset:96
  ds_read_b64_tr_b16 v[78:79], v250 offset:608
  s_add_u32 s49, s88, 122880
  s_add_u32 m0, s84, 12672
  s_nop 0
  buffer_load_dwordx4 v253, s[40:43], s49 offen offset:0 lds
  s_add_u32 m0, s84, 12448
  s_nop 0
  buffer_load_dwordx4 v253, s[40:43], s49 offen offset:1280 lds
  s_add_u32 m0, s84, 12224
  s_nop 0
  buffer_load_dwordx4 v253, s[40:43], s49 offen offset:2560 lds
  s_add_u32 m0, s84, 12000
  s_nop 0
  buffer_load_dwordx4 v253, s[40:43], s49 offen offset:3840 lds
  s_waitcnt vmcnt(8)
  ds_read_b64_tr_b16 v[80:81], v250 offset:4224
  ds_read_b64_tr_b16 v[82:83], v250 offset:4736
  ds_read_b64_tr_b16 v[84:85], v250 offset:4256
  ds_read_b64_tr_b16 v[86:87], v250 offset:4768
  ds_read_b64_tr_b16 v[88:89], v250 offset:4288
  ds_read_b64_tr_b16 v[90:91], v250 offset:4800
  ds_read_b64_tr_b16 v[92:93], v250 offset:4320
  ds_read_b64_tr_b16 v[94:95], v250 offset:4832
  s_add_u32 s49, s89, 0
  s_add_u32 m0, s84, 16896
  s_nop 0
  buffer_load_dwordx4 v253, s[40:43], s49 offen offset:0 lds
  s_add_u32 m0, s84, 16672
  s_nop 0
  buffer_load_dwordx4 v253, s[40:43], s49 offen offset:1280 lds
  s_add_u32 m0, s84, 16448
  s_nop 0
  buffer_load_dwordx4 v253, s[40:43], s49 offen offset:2560 lds
  s_add_u32 m0, s84, 16224
  s_nop 0
  buffer_load_dwordx4 v253, s[40:43], s49 offen offset:3840 lds
  s_waitcnt vmcnt(8)
  ds_read_b64_tr_b16 v[96:97], v250 offset:8448
  ds_read_b64_tr_b16 v[98:99], v250 offset:8960
  ds_read_b64_tr_b16 v[100:101], v250 offset:8480
  ds_read_b64_tr_b16 v[102:103], v250 offset:8992
  ds_read_b64_tr_b16 v[104:105], v250 offset:8512
  ds_read_b64_tr_b16 v[106:107], v250 offset:9024
  ds_read_b64_tr_b16 v[108:109], v250 offset:8544
  ds_read_b64_tr_b16 v[110:111], v250 offset:9056
  s_add_u32 s49, s89, 40960
  s_add_u32 m0, s84, 21120
  s_nop 0
  buffer_load_dwordx4 v253, s[40:43], s49 offen offset:0 lds
  s_add_u32 m0, s84, 20896
  s_nop 0
  buffer_load_dwordx4 v253, s[40:43], s49 offen offset:1280 lds
  s_add_u32 m0, s84, 20672
  s_nop 0
  buffer_load_dwordx4 v253, s[40:43], s49 offen offset:2560 lds
  s_add_u32 m0, s84, 20448
  s_nop 0
  buffer_load_dwordx4 v253, s[40:43], s49 offen offset:3840 lds
  s_waitcnt vmcnt(8)
  ds_read_b64_tr_b16 v[112:113], v250 offset:12672
  ds_read_b64_tr_b16 v[114:115], v250 offset:13184
  ds_read_b64_tr_b16 v[116:117], v250 offset:12704
  ds_read_b64_tr_b16 v[118:119], v250 offset:13216
  ds_read_b64_tr_b16 v[120:121], v250 offset:12736
  ds_read_b64_tr_b16 v[122:123], v250 offset:13248
  ds_read_b64_tr_b16 v[124:125], v250 offset:12768
  ds_read_b64_tr_b16 v[126:127], v250 offset:13280
  s_add_u32 s49, s89, 81920
  s_add_u32 m0, s84, 25344
  s_nop 0
  buffer_load_dwordx4 v253, s[40:43], s49 offen offset:0 lds
  s_add_u32 m0, s84, 25120
  s_nop 0
  buffer_load_dwordx4 v253, s[40:43], s49 offen offset:1280 lds
  s_add_u32 m0, s84, 24896
  s_nop 0
  buffer_load_dwordx4 v253, s[40:43], s49 offen offset:2560 lds
  s_add_u32 m0, s84, 24672
  s_nop 0
  buffer_load_dwordx4 v253, s[40:43], s49 offen offset:3840 lds
  s_waitcnt vmcnt(8)
  ds_read_b64_tr_b16 v[128:129], v250 offset:16896
  ds_read_b64_tr_b16 v[130:131], v250 offset:17408
  ds_read_b64_tr_b16 v[132:133], v250 offset:16928
  ds_read_b64_tr_b16 v[134:135], v250 offset:17440
  ds_read_b64_tr_b16 v[136:137], v250 offset:16960
  ds_read_b64_tr_b16 v[138:139], v250 offset:17472
  ds_read_b64_tr_b16 v[140:141], v250 offset:16992
  ds_read_b64_tr_b16 v[142:143], v250 offset:17504
  s_add_u32 s49, s89, 122880
  s_add_u32 m0, s84, 29568
  s_nop 0
  buffer_load_dwordx4 v253, s[40:43], s49 offen offset:0 lds
  s_add_u32 m0, s84, 29344
  s_nop 0
  buffer_load_dwordx4 v253, s[40:43], s49 offen offset:1280 lds
  s_add_u32 m0, s84, 29120
  s_nop 0
  buffer_load_dwordx4 v253, s[40:43], s49 offen offset:2560 lds
  s_add_u32 m0, s84, 28896
  s_nop 0
  buffer_load_dwordx4 v253, s[40:43], s49 offen offset:3840 lds
  s_waitcnt vmcnt(8)
  ds_read_b64_tr_b16 v[144:145], v250 offset:21120
  ds_read_b64_tr_b16 v[146:147], v250 offset:21632
  ds_read_b64_tr_b16 v[148:149], v250 offset:21152
  ds_read_b64_tr_b16 v[150:151], v250 offset:21664
  ds_read_b64_tr_b16 v[152:153], v250 offset:21184
  ds_read_b64_tr_b16 v[154:155], v250 offset:21696
  ds_read_b64_tr_b16 v[156:157], v250 offset:21216
  ds_read_b64_tr_b16 v[158:159], v250 offset:21728
  s_waitcnt vmcnt(4)
  ds_read_b64_tr_b16 v[160:161], v250 offset:25344
  ds_read_b64_tr_b16 v[162:163], v250 offset:25856
  ds_read_b64_tr_b16 v[164:165], v250 offset:25376
  ds_read_b64_tr_b16 v[166:167], v250 offset:25888
  ds_read_b64_tr_b16 v[168:169], v250 offset:25408
  ds_read_b64_tr_b16 v[170:171], v250 offset:25920
  ds_read_b64_tr_b16 v[172:173], v250 offset:25440
  ds_read_b64_tr_b16 v[174:175], v250 offset:25952
  s_waitcnt vmcnt(0)
  ds_read_b64_tr_b16 v[176:177], v250 offset:29568
  ds_read_b64_tr_b16 v[178:179], v250 offset:30080
  ds_read_b64_tr_b16 v[180:181], v250 offset:29600
  ds_read_b64_tr_b16 v[182:183], v250 offset:30112
  ds_read_b64_tr_b16 v[184:185], v250 offset:29632
  ds_read_b64_tr_b16 v[186:187], v250 offset:30144
  ds_read_b64_tr_b16 v[188:189], v250 offset:29664
  ds_read_b64_tr_b16 v[190:191], v250 offset:30176
  s_max_i32 s55, s55, 32769
  v_mov_b32 v5, s55
  ds_write_b32 v3, v5
  s_waitcnt lgkmcnt(0)
  s_branch L_tail3
L_slow:
  s_waitcnt lgkmcnt(0)
  ds_read_b128 v[232:235], v252 offset:0
  ds_read_b128 v[236:239], v252 offset:64
  ds_read_b128 v[240:243], v252 offset:128
  ds_read_b128 v[244:247], v252 offset:192
  s_waitcnt lgkmcnt(0)
  v_mfma_f32_16x16x32_bf16 v[168:171], v[232:235], v[96:99], 0
  v_mfma_f32_16x16x32_bf16 v[168:171], v[236:239], v[100:103], v[168:171]
  v_mfma_f32_16x16x32_bf16 v[168:171], v[240:243], v[104:107], v[168:171]
  v_mfma_f32_16x16x32_bf16 v[168:171], v[244:247], v[108:111], v[168:171]
  v_mfma_f32_16x16x32_bf16 v[172:175], v[244:247], v[124:127], 0
  v_mfma_f32_16x16x32_bf16 v[172:175], v[240:243], v[120:123], v[172:175]
  v_mfma_f32_16x16x32_bf16 v[172:175], v[236:239], v[116:119], v[172:175]
  v_mfma_f32_16x16x32_bf16 v[172:175], v[232:235], v[112:115], v[172:175]
  v_mfma_f32_16x16x32_bf16 v[176:179], v[232:235], v[128:131], 0
  v_mfma_f32_16x16x32_bf16 v[176:179], v[236:239], v[132:135], v[176:179]
  v_mfma_f32_16x16x32_bf16 v[176:179], v[240:243], v[136:139], v[176:179]
  v_mfma_f32_16x16x32_bf16 v[176:179], v[244:247], v[140:143], v[176:179]
  s_nop 7
  v_max3_f32 v192, v168, v169, v170
  v_max_f32 v192, v192, v171
  v_max3_f32 v196, v172, v173, v174
  v_max_f32 v196, v196, v175
  v_max3_f32 v200, v176, v177, v178
  v_max_f32 v200, v200, v179
  ds_read_b128 v[232:235], v252 offset:512
  ds_read_b128 v[236:239], v252 offset:576
  ds_read_b128 v[240:243], v252 offset:640
  ds_read_b128 v[244:247], v252 offset:704
  s_waitcnt lgkmcnt(0)
  v_mfma_f32_16x16x32_bf16 v[168:171], v[232:235], v[96:99], 0
  v_mfma_f32_16x16x32_bf16 v[168:171], v[236:239], v[100:103], v[168:171]
  v_mfma_f32_16x16x32_bf16 v[168:171], v[240:243], v[104:107], v[168:171]
  v_mfma_f32_16x16x32_bf16 v[168:171], v[244:247], v[108:111], v[168:171]
  v_mfma_f32_16x16x32_bf16 v[172:175], v[244:247], v[124:127], 0
  v_mfma_f32_16x16x32_bf16 v[172:175], v[240:243], v[120:123], v[172:175]
  v_mfma_f32_16x16x32_bf16 v[172:175], v[236:239], v[116:119], v[172:175]
  v_mfma_f32_16x16x32_bf16 v[172:175], v[232:235], v[112:115], v[172:175]
  v_mfma_f32_16x16x32_bf16 v[176:179], v[232:235], v[128:131], 0
  v_mfma_f32_16x16x32_bf16 v[176:179], v[236:239], v[132:135], v[176:179]
  v_mfma_f32_16x16x32_bf16 v[176:179], v[240:243], v[136:139], v[176:179]
  v_mfma_f32_16x16x32_bf16 v[176:179], v[244:247], v[140:143], v[176:179]
  s_nop 7
  v_max3_f32 v192, v192, v168, v169
  v_max3_f32 v192, v192, v170, v171
  v_max3_f32 v196, v196, v172, v173
  v_max3_f32 v196, v196, v174, v175
  v_max3_f32 v200, v200, v176, v177
  v_max3_f32 v200, v200, v178, v179
  ds_read_b128 v[232:235], v252 offset:16896
  ds_read_b128 v[236:239], v252 offset:16960
  ds_read_b128 v[240:243], v252 offset:17024
  ds_read_b128 v[244:247], v252 offset:17088
  s_waitcnt lgkmcnt(0)
  v_mfma_f32_16x16x32_bf16 v[168:171], v[232:235], v[96:99], 0
  v_mfma_f32_16x16x32_bf16 v[168:171], v[236:239], v[100:103], v[168:171]
  v_mfma_f32_16x16x32_bf16 v[168:171], v[240:243], v[104:107], v[168:171]
  v_mfma_f32_16x16x32_bf16 v[168:171], v[244:247], v[108:111], v[168:171]
  v_mfma_f32_16x16x32_bf16 v[172:175], v[244:247], v[124:127], 0
  v_mfma_f32_16x16x32_bf16 v[172:175], v[240:243], v[120:123], v[172:175]
  v_mfma_f32_16x16x32_bf16 v[172:175], v[236:239], v[116:119], v[172:175]
  v_mfma_f32_16x16x32_bf16 v[172:175], v[232:235], v[112:115], v[172:175]
  v_mfma_f32_16x16x32_bf16 v[176:179], v[232:235], v[128:131], 0
  v_mfma_f32_16x16x32_bf16 v[176:179], v[236:239], v[132:135], v[176:179]
  v_mfma_f32_16x16x32_bf16 v[176:179], v[240:243], v[136:139], v[176:179]
  v_mfma_f32_16x16x32_bf16 v[176:179], v[244:247], v[140:143], v[176:179]
  s_nop 7
  v_max3_f32 v192, v192, v168, v169
  v_max3_f32 v192, v192, v170, v171
  v_max3_f32 v196, v196, v172, v173
  v_max3_f32 v196, v196, v174, v175
  v_max3_f32 v200, v200, v176, v177
  v_max3_f32 v200, v200, v178, v179
  ds_read_b128 v[232:235], v252 offset:17408
  ds_read_b128 v[236:239], v252 offset:17472
  ds_read_b128 v[240:243], v252 offset:17536
  ds_read_b128 v[244:247], v252 offset:17600
  s_waitcnt lgkmcnt(0)
  v_mfma_f32_16x16x32_bf16 v[168:171], v[232:235], v[96:99], 0
  v_mfma_f32_16x16x32_bf16 v[168:171], v[236:239], v[100:103], v[168:171]
  v_mfma_f32_16x16x32_bf16 v[168:171], v[240:243], v[104:107], v[168:171]
  v_mfma_f32_16x16x32_bf16 v[168:171], v[244:247], v[108:111], v[168:171]
  v_mfma_f32_16x16x32_bf16 v[172:175], v[244:247], v[124:127], 0
  v_mfma_f32_16x16x32_bf16 v[172:175], v[240:243], v[120:123], v[172:175]
  v_mfma_f32_16x16x32_bf16 v[172:175], v[236:239], v[116:119], v[172:175]
  v_mfma_f32_16x16x32_bf16 v[172:175], v[232:235], v[112:115], v[172:175]
  v_mfma_f32_16x16x32_bf16 v[176:179], v[232:235], v[128:131], 0
  v_mfma_f32_16x16x32_bf16 v[176:179], v[236:239], v[132:135], v[176:179]
  v_mfma_f32_16x16x32_bf16 v[176:179], v[240:243], v[136:139], v[176:179]
  v_mfma_f32_16x16x32_bf16 v[176:179], v[244:247], v[140:143], v[176:179]
  s_nop 7
  v_max3_f32 v192, v192, v168, v169
  v_max3_f32 v192, v192, v170, v171
  v_max3_f32 v196, v196, v172, v173
  v_max3_f32 v196, v196, v174, v175
  v_max3_f32 v200, v200, v176, v177
  v_max3_f32 v200, v200, v178, v179
  ds_read_b128 v[216:219], v252 offset:0
  ds_read_b128 v[220:223], v252 offset:64
  ds_read_b128 v[224:227], v252 offset:128
  ds_read_b128 v[228:231], v252 offset:192
  v_mov_b32 v193, v192
  v_mov_b32 v197, v196
  v_mov_b32 v201, v200
  s_nop 1
  v_permlane32_swap_b32 v192, v193
  v_permlane32_swap_b32 v196, v197
  v_permlane32_swap_b32 v200, v201
  s_nop 1
  v_max_f32 v192, v192, v193
  v_max_f32 v196, v196, v197
  v_max_f32 v200, v200, v201
  v_mov_b32 v193, v192
  v_mov_b32 v197, v196
  v_mov_b32 v201, v200
  s_nop 1
  v_permlane16_swap_b32 v192, v193
  v_permlane16_swap_b32 v196, v197
  v_permlane16_swap_b32 v200, v201
  s_nop 1
  v_max_f32 v192, v192, v193
  v_max_f32 v196, v196, v197
  v_max_f32 v200, v200, v201
  v_add_f32 v192, 0x40e00000, v192
  v_max_f32_e64 v192, -v156, v192
  v_sub_f32_e64 v194, -v156, v192
  v_exp_f32 v194, v194
  v_mul_f32 v156, -1.0, v192
  v_mul_f32 v157, -1.0, v192
  v_mul_f32 v158, -1.0, v192
  v_mul_f32 v159, -1.0, v192
  v_add_f32 v196, 0x40e00000, v196
  v_max_f32_e64 v196, -v160, v196
  v_sub_f32_e64 v198, -v160, v196
  v_exp_f32 v198, v198
  v_mul_f32 v160, -1.0, v196
  v_mul_f32 v161, -1.0, v196
  v_mul_f32 v162, -1.0, v196
  v_mul_f32 v163, -1.0, v196
  v_add_f32 v200, 0x40e00000, v200
  v_max_f32_e64 v200, -v164, v200
  v_sub_f32_e64 v202, -v164, v200
  v_exp_f32 v202, v202
  v_mul_f32 v164, -1.0, v200
  v_mul_f32 v165, -1.0, v200
  v_mul_f32 v166, -1.0, v200
  v_mul_f32 v167, -1.0, v200
  v_pk_mul_f32 v[0:1], v[0:1], v[194:195] op_sel_hi:[1,0]
  v_pk_mul_f32 v[2:3], v[2:3], v[194:195] op_sel_hi:[1,0]
  v_pk_mul_f32 v[12:13], v[12:13], v[194:195] op_sel_hi:[1,0]
  v_pk_mul_f32 v[14:15], v[14:15], v[194:195] op_sel_hi:[1,0]
  v_pk_mul_f32 v[24:25], v[24:25], v[194:195] op_sel_hi:[1,0]
  v_pk_mul_f32 v[26:27], v[26:27], v[194:195] op_sel_hi:[1,0]
  v_pk_mul_f32 v[36:37], v[36:37], v[194:195] op_sel_hi:[1,0]
  v_pk_mul_f32 v[38:39], v[38:39], v[194:195] op_sel_hi:[1,0]
  v_pk_mul_f32 v[48:49], v[48:49], v[194:195] op_sel_hi:[1,0]
  v_pk_mul_f32 v[50:51], v[50:51], v[194:195] op_sel_hi:[1,0]
  v_pk_mul_f32 v[60:61], v[60:61], v[194:195] op_sel_hi:[1,0]
  v_pk_mul_f32 v[62:63], v[62:63], v[194:195] op_sel_hi:[1,0]
  v_pk_mul_f32 v[72:73], v[72:73], v[194:195] op_sel_hi:[1,0]
  v_pk_mul_f32 v[74:75], v[74:75], v[194:195] op_sel_hi:[1,0]
  v_pk_mul_f32 v[84:85], v[84:85], v[194:195] op_sel_hi:[1,0]
  v_pk_mul_f32 v[86:87], v[86:87], v[194:195] op_sel_hi:[1,0]
  v_pk_mul_f32 v[144:145], v[144:145], v[194:195] op_sel_hi:[1,0]
  v_pk_mul_f32 v[4:5], v[4:5], v[198:199] op_sel_hi:[1,0]
  v_pk_mul_f32 v[6:7], v[6:7], v[198:199] op_sel_hi:[1,0]
  v_pk_mul_f32 v[16:17], v[16:17], v[198:199] op_sel_hi:[1,0]
  v_pk_mul_f32 v[18:19], v[18:19], v[198:199] op_sel_hi:[1,0]
  v_pk_mul_f32 v[28:29], v[28:29], v[198:199] op_sel_hi:[1,0]
  v_pk_mul_f32 v[30:31], v[30:31], v[198:199] op_sel_hi:[1,0]
  v_pk_mul_f32 v[40:41], v[40:41], v[198:199] op_sel_hi:[1,0]
  v_pk_mul_f32 v[42:43], v[42:43], v[198:199] op_sel_hi:[1,0]
  v_pk_mul_f32 v[52:53], v[52:53], v[198:199] op_sel_hi:[1,0]
  v_pk_mul_f32 v[54:55], v[54:55], v[198:199] op_sel_hi:[1,0]
  v_pk_mul_f32 v[64:65], v[64:65], v[198:199] op_sel_hi:[1,0]
  v_pk_mul_f32 v[66:67], v[66:67], v[198:199] op_sel_hi:[1,0]
  v_pk_mul_f32 v[76:77], v[76:77], v[198:199] op_sel_hi:[1,0]
  v_pk_mul_f32 v[78:79], v[78:79], v[198:199] op_sel_hi:[1,0]
  v_pk_mul_f32 v[88:89], v[88:89], v[198:199] op_sel_hi:[1,0]
  v_pk_mul_f32 v[90:91], v[90:91], v[198:199] op_sel_hi:[1,0]
  v_pk_mul_f32 v[146:147], v[146:147], v[198:199] op_sel_hi:[1,0]
  v_pk_mul_f32 v[8:9], v[8:9], v[202:203] op_sel_hi:[1,0]
  v_pk_mul_f32 v[10:11], v[10:11], v[202:203] op_sel_hi:[1,0]
  v_pk_mul_f32 v[20:21], v[20:21], v[202:203] op_sel_hi:[1,0]
  v_pk_mul_f32 v[22:23], v[22:23], v[202:203] op_sel_hi:[1,0]
  v_pk_mul_f32 v[32:33], v[32:33], v[202:203] op_sel_hi:[1,0]
  v_pk_mul_f32 v[34:35], v[34:35], v[202:203] op_sel_hi:[1,0]
  v_pk_mul_f32 v[44:45], v[44:45], v[202:203] op_sel_hi:[1,0]
  v_pk_mul_f32 v[46:47], v[46:47], v[202:203] op_sel_hi:[1,0]
  v_pk_mul_f32 v[56:57], v[56:57], v[202:203] op_sel_hi:[1,0]
  v_pk_mul_f32 v[58:59], v[58:59], v[202:203] op_sel_hi:[1,0]
  v_pk_mul_f32 v[68:69], v[68:69], v[202:203] op_sel_hi:[1,0]
  v_pk_mul_f32 v[70:71], v[70:71], v[202:203] op_sel_hi:[1,0]
  v_pk_mul_f32 v[80:81], v[80:81], v[202:203] op_sel_hi:[1,0]
  v_pk_mul_f32 v[82:83], v[82:83], v[202:203] op_sel_hi:[1,0]
  v_pk_mul_f32 v[92:93], v[92:93], v[202:203] op_sel_hi:[1,0]
  v_pk_mul_f32 v[94:95], v[94:95], v[202:203] op_sel_hi:[1,0]
  v_pk_mul_f32 v[148:149], v[148:149], v[202:203] op_sel_hi:[1,0]
  s_sub_u32 s63, s63, 1
  s_cbranch_scc1 L_end
  s_nop 1
  s_branch L_body
L_spin_v:
  s_sleep 1
  s_sub_u32 s63, s63, 1
  s_cbranch_scc1 L_end
  ds_read_addtid_b32 v255 offset:0
  s_waitcnt lgkmcnt(0)
  v_cmp_gt_u32 vcc, s44, v255
  s_nop 1
  s_cbranch_vccnz L_spin_v
  s_branch L_spun_v
L_spin_k:
  s_sleep 1
  s_sub_u32 s63, s63, 1
  s_cbranch_scc1 L_end
  ds_read_addtid_b32 v255 offset:0
  s_waitcnt lgkmcnt(0)
  v_cmp_gt_u32 vcc, s44, v255
  s_nop 1
  s_cbranch_vccnz L_spin_k
  s_branch L_spun_k
L_spin_init:
  s_sleep 1
  s_sub_u32 s63, s63, 1
  s_cbranch_scc1 L_end
  ds_read_addtid_b32 v255 offset:0
  s_waitcnt lgkmcnt(0)
  v_cmp_gt_u32 vcc, 129, v255
  s_nop 1
  s_cbranch_vccnz L_spin_init
  s_branch L_spun_init
L_notile:
  s_mov_b64 exec, 1
  s_waitcnt vmcnt(0)
  buffer_store_dword v1, v0, s[36:39], s101 offen offset:0 sc1
  s_mov_b64 exec, -1
  s_branch L_tail_done
L_st_no:
  s_mov_b64 exec, 1
  s_waitcnt vmcnt(0)
  buffer_store_dword v1, v0, s[36:39], s101 offen offset:0 sc1
  s_mov_b64 exec, -1
  s_mov_b32 s96, 1
  s_branch L_st
L_fill0:
  v_add_u32 v244, 137216, v248
  ds_read_b64_tr_b16 v[64:65], v244 offset:0
  ds_read_b64_tr_b16 v[66:67], v244 offset:512
  ds_read_b64_tr_b16 v[68:69], v244 offset:32
  ds_read_b64_tr_b16 v[70:71], v244 offset:544
  ds_read_b64_tr_b16 v[72:73], v244 offset:64
  ds_read_b64_tr_b16 v[74:75], v244 offset:576
  ds_read_b64_tr_b16 v[76:77], v244 offset:96
  ds_read_b64_tr_b16 v[78:79], v244 offset:608
  ds_read_b64_tr_b16 v[80:81], v244 offset:4224
  ds_read_b64_tr_b16 v[82:83], v244 offset:4736
  ds_read_b64_tr_b16 v[84:85], v244 offset:4256
  ds_read_b64_tr_b16 v[86:87], v244 offset:4768
  ds_read_b64_tr_b16 v[88:89], v244 offset:4288
  ds_read_b64_tr_b16 v[90:91], v244 offset:4800
  ds_read_b64_tr_b16 v[92:93], v244 offset:4320
  ds_read_b64_tr_b16 v[94:95], v244 offset:4832
  s_waitcnt lgkmcnt(8)
  ds_read_b64_tr_b16 v[96:97], v244 offset:8448
  ds_read_b64_tr_b16 v[98:99], v244 offset:8960
  ds_read_b64_tr_b16 v[100:101], v244 offset:8480
  ds_read_b64_tr_b16 v[102:103], v244 offset:8992
  ds_read_b64_tr_b16 v[104:105], v244 offset:8512
  ds_read_b64_tr_b16 v[106:107], v244 offset:9024
  ds_read_b64_tr_b16 v[108:109], v244 offset:8544
  ds_read_b64_tr_b16 v[110:111], v244 offset:9056
  s_waitcnt lgkmcnt(8)
  ds_read_b64_tr_b16 v[112:113], v244 offset:12672
  ds_read_b64_tr_b16 v[114:115], v244 offset:13184
  ds_read_b64_tr_b16 v[116:117], v244 offset:12704
  ds_read_b64_tr_b16 v[118:119], v244 offset:13216
  ds_read_b64_tr_b16 v[120:121], v244 offset:12736
  ds_read_b64_tr_b16 v[122:123], v244 offset:13248
  ds_read_b64_tr_b16 v[124:125], v244 offset:12768
  ds_read_b64_tr_b16 v[126:127], v244 offset:13280
  s_waitcnt lgkmcnt(8)
  ds_read_b64_tr_b16 v[128:129], v244 offset:16896
  ds_read_b64_tr_b16 v[130:131], v244 offset:17408
  ds_read_b64_tr_b16 v[132:133], v244 offset:16928
  ds_read_b64_tr_b16 v[134:135], v244 offset:17440
  ds_read_b64_tr_b16 v[136:137], v244 offset:16960
  ds_read_b64_tr_b16 v[138:139], v244 offset:17472
  ds_read_b64_tr_b16 v[140:141], v244 offset:16992
  ds_read_b64_tr_b16 v[142:143], v244 offset:17504
  s_waitcnt lgkmcnt(8)
  ds_read_b64_tr_b16 v[144:145], v244 offset:21120
  ds_read_b64_tr_b16 v[146:147], v244 offset:21632
  ds_read_b64_tr_b16 v[148:149], v244 offset:21152
  ds_read_b64_tr_b16 v[150:151], v244 offset:21664
  ds_read_b64_tr_b16 v[152:153], v244 offset:21184
  ds_read_b64_tr_b16 v[154:155], v244 offset:21696
  ds_read_b64_tr_b16 v[156:157], v244 offset:21216
  ds_read_b64_tr_b16 v[158:159], v244 offset:21728
  s_waitcnt lgkmcnt(8)
  s_cmp_lg_u32 s96, 0
  s_cbranch_scc1 L_f0d
  s_mov_b64 exec, 1
  s_waitcnt vmcnt(0)
  buffer_store_dword v1, v0, s[36:39], s101 offen offset:0 sc1
  s_mov_b64 exec, -1
L_f0d:
  ds_read_b64_tr_b16 v[160:161], v250 offset:25344
  ds_read_b64_tr_b16 v[162:163], v250 offset:25856
  ds_read_b64_tr_b16 v[164:165], v250 offset:25376
  ds_read_b64_tr_b16 v[166:167], v250 offset:25888
  ds_read_b64_tr_b16 v[168:169], v250 offset:25408
  ds_read_b64_tr_b16 v[170:171], v250 offset:25920
  ds_read_b64_tr_b16 v[172:173], v250 offset:25440
  ds_read_b64_tr_b16 v[174:175], v250 offset:25952
  s_waitcnt lgkmcnt(8)
  ds_read_b64_tr_b16 v[176:177], v250 offset:29568
  ds_read_b64_tr_b16 v[178:179], v250 offset:30080
  ds_read_b64_tr_b16 v[180:181], v250 offset:29600
  ds_read_b64_tr_b16 v[182:183], v250 offset:30112
  ds_read_b64_tr_b16 v[184:185], v250 offset:29632
  ds_read_b64_tr_b16 v[186:187], v250 offset:30144
  ds_read_b64_tr_b16 v[188:189], v250 offset:29664
  ds_read_b64_tr_b16 v[190:191], v250 offset:30176
  s_waitcnt lgkmcnt(0)
  s_add_u32 s49, s91, 81920
  s_add_u32 m0, s84, 25344
  s_nop 0
  buffer_load_dwordx4 v253, s[40:43], s49 offen offset:0 lds
  s_add_u32 m0, s84, 25120
  s_nop 0
  buffer_load_dwordx4 v253, s[40:43], s49 offen offset:1280 lds
  s_add_u32 m0, s84, 24896
  s_nop 0
  buffer_load_dwordx4 v253, s[40:43], s49 offen offset:2560 lds
  s_add_u32 m0, s84, 24672
  s_nop 0
  buffer_load_dwordx4 v253, s[40:43], s49 offen offset:3840 lds
  s_add_u32 s49, s91, 122880
  s_add_u32 m0, s84, 29568
  s_nop 0
  buffer_load_dwordx4 v253, s[40:43], s49 offen offset:0 lds
  s_add_u32 m0, s84, 29344
  s_nop 0
  buffer_load_dwordx4 v253, s[40:43], s49 offen offset:1280 lds
  s_add_u32 m0, s84, 29120
  s_nop 0
  buffer_load_dwordx4 v253, s[40:43], s49 offen offset:2560 lds
  s_add_u32 m0, s84, 28896
  s_nop 0
  buffer_load_dwordx4 v253, s[40:43], s49 offen offset:3840 lds
  s_waitcnt vmcnt(0)
  s_branch L_tail3
L_fst:
  s_mov_b64 exec, 1
  s_waitcnt vmcnt(8)
  buffer_store_dword v1, v0, s[36:39], s101 offen offset:0 sc1
  s_mov_b64 exec, -1
  s_branch L_fsd
L_rpoll0:
  s_sub_u32 s63, s63, 1
  s_cbranch_scc1 L_end
  buffer_load_dword v255, v254, s[36:39], s97 offen offset:0 sc1
  s_waitcnt vmcnt(0)
  v_cmp_ne_u32 vcc, v251, v255
  s_nop 1
  s_and_b32 s96, vcc_lo, vcc_hi
  s_bitcmp1_b32 s96, s51
  s_cbranch_scc1 L_rchk0
  s_sleep 4
  s_branch L_rpoll0
L_rpoll1:
  s_sub_u32 s63, s63, 1
  s_cbranch_scc1 L_end
  buffer_load_dword v255, v254, s[36:39], s97 offen offset:0 sc1
  s_waitcnt vmcnt(0)
  v_cmp_ne_u32 vcc, v251, v255
  s_nop 1
  s_and_b32 s96, vcc_lo, vcc_hi
  s_bitcmp1_b32 s96, s51
  s_cbranch_scc1 L_rchk1
  s_sleep 4
  s_branch L_rpoll1
L_rpoll2:
  s_sub_u32 s63, s63, 1
  s_cbranch_scc1 L_end
  buffer_load_dword v255, v254, s[36:39], s97 offen offset:0 sc1
  s_waitcnt vmcnt(0)
  v_cmp_ne_u32 vcc, v251, v255
  s_nop 1
  s_and_b32 s96, vcc_lo, vcc_hi
  s_bitcmp1_b32 s96, s51
  s_cbranch_scc1 L_rchk2
  s_sleep 4
  s_branch L_rpoll2
L_rpoll3:
  s_sub_u32 s63, s63, 1
  s_cbranch_scc1 L_end
  buffer_load_dword v255, v254, s[36:39], s97 offen offset:0 sc1
  s_waitcnt vmcnt(0)
  v_cmp_ne_u32 vcc, v251, v255
  s_nop 1
  s_and_b32 s96, vcc_lo, vcc_hi
  s_bitcmp1_b32 s96, s51
  s_cbranch_scc1 L_rchk3
  s_sleep 4
  s_branch L_rpoll3
L_hfin:
  s_waitcnt lgkmcnt(0)
  s_barrier
  s_branch L_tail_done
L_compute:
  v_lshlrev_b32 v2, 3, v0
  v_mov_b64 v[4:5], 0
  ds_write_b64 v2, v[4:5]
  s_setprio 2
  s_lshl_b32 s49, s21, 2
  s_add_u32 s49, s49, s20
  s_lshl_b32 s49, s49, 5
  s_add_u32 s49, s49, s22
  s_lshl_b32 s101, s49, 2
  s_add_u32 s101, s101, 25165824
  s_lshl_b32 s49, s21, 5
  s_add_u32 s49, s49, s22
  s_mul_i32 s54, s49, 49152
  s_mul_i32 s49, s20, 3072
  s_add_u32 s54, s54, s49
  s_lshl2_add_u32 s49, s2, s20
  s_lshl_b32 s28, s49, 12
  s_add_u32 s28, s28, 16777216
  s_lshl_b32 s29, s49, 7
  s_add_u32 s29, s29, 25231360
  v_and_b32 v1, 63, v0
  v_and_b32 v2, 15, v1
  v_lshrrev_b32 v3, 4, v1
  s_mul_i32 s49, s20, 6144
  s_add_u32 s49, s49, 103424
  v_lshrrev_b32 v4, 1, v2
  v_xor_b32 v4, v4, v3
  v_lshlrev_b32 v4, 4, v4
  v_lshl_add_u32 v4, v2, 7, v4
  v_add_u32 v248, s49, v4
  v_xor_b32 v4, 64, v4
  v_add_u32 v249, s49, v4
  v_lshrrev_b32 v5, 2, v1
  v_and_b32 v6, 7, v5
  v_mul_u32_u24 v6, 1056, v6
  v_lshrrev_b32 v5, 3, v5
  v_lshl_add_u32 v6, v5, 8, v6
  v_and_b32 v5, 3, v1
  v_lshl_add_u32 v252, v5, 3, v6
  v_add_u32 v250, 137216, v252
  v_add_u32 v252, 103424, v252
  v_lshl_add_u32 v253, v5, 3, v6
  v_add_u32 v253, 10496, v253
  v_and_b32 v6, 7, v2
  v_mul_u32_u24 v6, 1056, v6
  v_lshrrev_b32 v5, 3, v2
  v_lshl_add_u32 v6, v5, 8, v6
  v_lshl_add_u32 v6, v3, 4, v6
  v_add_u32 v254, 2048, v6
  s_lshl_b32 m0, s20, 9
  s_lshr_b32 s50, s2, 3
  s_mul_i32 s56, s50, 26
  s_lshr_b32 s56, s56, 8
  s_mul_i32 s57, s56, 10
  s_sub_u32 s57, s50, s57
  s_add_u32 s100, s57, s56
  s_lshl_b32 s57, s57, 7
  s_bfe_u32 s49, s2, 0x20001
  s_mul_i32 s49, s49, 3
  s_add_u32 s49, s49, s56
  s_and_b32 s50, s2, 1
  s_lshl1_add_u32 s49, s49, s50
  s_and_b32 s51, s62, 3
  s_lshl2_add_u32 s59, s49, s51
  s_mul_i32 s98, s59, 20480
  s_add_u32 s98, s98, s57
  s_lshl2_add_u32 s99, s50, s51
  s_lshl_b32 s99, s99, 2
  s_add_u32 s51, s51, 3
  s_and_b32 s51, s51, 3
  s_mul_i32 s84, s51, 33792
  s_add_u32 s84, s84, 2048
  s_add_u32 s85, s51, 29
  s_max_u32 s85, s85, 29
  s_lshl_b32 s85, s85, 5
  s_add_u32 s85, s85, 2064
  s_cmp_lt_u32 s62, 4
  s_cselect_b32 s50, 1, 0
  s_xor_b32 s49, s49, s50
  s_min_u32 s49, s49, 23
  s_mul_i32 s58, s49, 43
  s_lshr_b32 s58, s58, 7
  s_mul_i32 s59, s58, 3
  s_sub_u32 s59, s49, s59
  s_lshl2_add_u32 s49, s58, s59
  s_lshl_b32 s97, s49, 7
  s_add_u32 s97, s97, 25165824
  s_lshl_b32 s58, s58, 5
  s_lshl_b32 s59, s59, 12
  s_add_u32 s49, s100, 0
  s_and_b32 s49, s49, 3
  s_add_u32 s49, s49, s99
  s_add_u32 s50, s49, s58
  s_mul_i32 s92, s50, 49152
  s_add_u32 s92, s92, s59
  s_mul_i32 s88, s49, 163840
  s_add_u32 s88, s88, s57
  s_add_u32 s49, s100, 1
  s_and_b32 s49, s49, 3
  s_add_u32 s49, s49, s99
  s_add_u32 s50, s49, s58
  s_mul_i32 s93, s50, 49152
  s_add_u32 s93, s93, s59
  s_mul_i32 s89, s49, 163840
  s_add_u32 s89, s89, s57
  s_add_u32 s49, s100, 2
  s_and_b32 s49, s49, 3
  s_add_u32 s49, s49, s99
  s_add_u32 s50, s49, s58
  s_mul_i32 s94, s50, 49152
  s_add_u32 s94, s94, s59
  s_mul_i32 s90, s49, 163840
  s_add_u32 s90, s90, s57
  s_add_u32 s49, s100, 3
  s_and_b32 s49, s49, 3
  s_add_u32 s49, s49, s99
  s_add_u32 s50, s49, s58
  s_mul_i32 s95, s50, 49152
  s_add_u32 s95, s95, s59
  s_mul_i32 s91, s49, 163840
  s_add_u32 s91, s91, s57
  s_waitcnt lgkmcnt(0)
  s_mov_b32 s36, s18
  s_mov_b32 s37, s19
  s_mov_b32 s38, 33554432
  s_mov_b32 s39, 0x20000
  s_mov_b32 s40, s12
  s_mov_b32 s41, s13
  s_mov_b32 s42, 5242880
  s_mov_b32 s43, 0x20000
  s_mov_b32 s80, s14
  s_mov_b32 s81, s15
  s_mov_b32 s82, 1966080
  s_mov_b32 s83, 0x20000
  v_mov_b32 v245, v1
  v_lshlrev_b32 v2, 2, v1
  v_mov_b32 v0, 0
  buffer_load_dword v251, v2, s[36:39], s97 offen offset:0 sc1
  buffer_load_dword v200, v0, s[36:39], s101 offen offset:0 sc1
  buffer_load_dword v201, v0, s[36:39], s29 offen offset:0 sc1
  s_xor_b32 s49, s29, 512
  buffer_load_dword v202, v0, s[36:39], s49 offen offset:0 sc1
  v_mov_b32 v1, 0
  v_mov_b64 v[2:3], 0
  v_mov_b64 v[4:5], 0
  v_mov_b64 v[6:7], 0
  v_mov_b64 v[8:9], 0
  v_mov_b64 v[10:11], 0
  v_mov_b64 v[12:13], 0
  v_mov_b64 v[14:15], 0
  v_mov_b64 v[16:17], 0
  v_mov_b64 v[18:19], 0
  v_mov_b64 v[20:21], 0
  v_mov_b64 v[22:23], 0
  v_mov_b64 v[24:25], 0
  v_mov_b64 v[26:27], 0
  v_mov_b64 v[28:29], 0
  v_mov_b64 v[30:31], 0
  v_mov_b64 v[32:33], 0
  v_mov_b64 v[34:35], 0
  v_mov_b64 v[36:37], 0
  v_mov_b64 v[38:39], 0
  v_mov_b64 v[40:41], 0
  v_mov_b64 v[42:43], 0
  v_mov_b64 v[44:45], 0
  v_mov_b64 v[46:47], 0
  v_mov_b64 v[48:49], 0
  v_mov_b64 v[50:51], 0
  v_mov_b64 v[52:53], 0
  v_mov_b64 v[54:55], 0
  v_mov_b64 v[56:57], 0
  v_mov_b64 v[58:59], 0
  v_mov_b64 v[60:61], 0
  v_mov_b64 v[62:63], 0
  v_mov_b64 v[64:65], 0
  v_mov_b64 v[66:67], 0
  v_mov_b64 v[68:69], 0
  v_mov_b64 v[70:71], 0
  v_mov_b64 v[72:73], 0
  v_mov_b64 v[74:75], 0
  v_mov_b64 v[76:77], 0
  v_mov_b64 v[78:79], 0
  v_mov_b64 v[80:81], 0
  v_mov_b64 v[82:83], 0
  v_mov_b64 v[84:85], 0
  v_mov_b64 v[86:87], 0
  v_mov_b64 v[88:89], 0
  v_mov_b64 v[90:91], 0
  v_mov_b64 v[92:93], 0
  v_mov_b64 v[94:95], 0
  s_mov_b32 s44, 0
  s_mov_b32 s46, 33792
  s_mov_b32 s52, 0
  s_mov_b32 s51, 8448
  s_mov_b32 s58, 0x3e0293ee
  s_mov_b32 s59, 0x3e0293ee
  s_waitcnt lgkmcnt(0)
  s_barrier
  ds_read_b128 v[152:155], v248 offset:0
  ds_read_b128 v[164:167], v249 offset:0
  ds_read_b64_tr_b16 v[216:217], v252 offset:24576
  ds_read_b64_tr_b16 v[218:219], v252 offset:25088
  ds_read_b64_tr_b16 v[220:221], v250 offset:0
  ds_read_b64_tr_b16 v[222:223], v250 offset:512
  ds_read_b128 v[156:159], v248 offset:2048
  ds_read_b128 v[168:171], v249 offset:2048
  ds_read_b128 v[160:163], v248 offset:4096
  ds_read_b128 v[172:175], v249 offset:4096
  ds_read_b64_tr_b16 v[224:225], v252 offset:24608
  ds_read_b64_tr_b16 v[226:227], v252 offset:25120
  ds_read_b64_tr_b16 v[228:229], v250 offset:32
  ds_read_b64_tr_b16 v[230:231], v250 offset:544
L_qloop:
  s_waitcnt lgkmcnt(8)
  v_mfma_f32_16x16x32_bf16 v[0:3], v[216:219], v[152:155], v[0:3]
  ds_read_b64_tr_b16 v[232:233], v252 offset:24640
  v_mfma_f32_16x16x32_bf16 v[0:3], v[220:223], v[164:167], v[0:3]
  ds_read_b64_tr_b16 v[234:235], v252 offset:25152
  s_cmp_eq_u32 s52, 0
  s_waitcnt lgkmcnt(8)
  v_mfma_f32_16x16x32_bf16 v[4:7], v[220:223], v[168:171], v[4:7]
  ds_read_b64_tr_b16 v[236:237], v250 offset:64
  s_cselect_b32 s45, 0xfffef800, s46
  v_mfma_f32_16x16x32_bf16 v[4:7], v[216:219], v[156:159], v[4:7]
  ds_read_b64_tr_b16 v[238:239], v250 offset:576
  s_waitcnt lgkmcnt(8)
  v_mfma_f32_16x16x32_bf16 v[8:11], v[216:219], v[160:163], v[8:11]
  ds_read_b64_tr_b16 v[240:241], v252 offset:24672
  v_add_u32 v248, s45, v248
  v_mfma_f32_16x16x32_bf16 v[8:11], v[220:223], v[172:175], v[8:11]
  ds_read_b64_tr_b16 v[242:243], v252 offset:25184
  v_add_u32 v249, s45, v249
  s_waitcnt lgkmcnt(6)
  v_mfma_f32_16x16x32_bf16 v[20:23], v[228:231], v[172:175], v[20:23]
  ds_read_b64_tr_b16 v[244:245], v250 offset:96
  v_mfma_f32_16x16x32_bf16 v[20:23], v[224:227], v[160:163], v[20:23]
  ds_read_b64_tr_b16 v[246:247], v250 offset:608
  s_add_u32 s52, s52, 1
  v_mfma_f32_16x16x32_bf16 v[16:19], v[224:227], v[156:159], v[16:19]
  s_cmp_eq_u32 s52, 3
  v_mfma_f32_16x16x32_bf16 v[16:19], v[228:231], v[168:171], v[16:19]
  s_cselect_b32 s52, 0, s52
  v_mfma_f32_16x16x32_bf16 v[12:15], v[228:231], v[164:167], v[12:15]
  s_cselect_b32 s57, 0xffffbe00, s51
  v_mfma_f32_16x16x32_bf16 v[12:15], v[224:227], v[152:155], v[12:15]
  s_waitcnt lgkmcnt(4)
  v_mfma_f32_16x16x32_bf16 v[24:27], v[232:235], v[152:155], v[24:27]
  ds_read_b64_tr_b16 v[216:217], v252 offset:24704
  v_mfma_f32_16x16x32_bf16 v[24:27], v[236:239], v[164:167], v[24:27]
  ds_read_b64_tr_b16 v[218:219], v252 offset:25216
  v_mfma_f32_16x16x32_bf16 v[28:31], v[236:239], v[168:171], v[28:31]
  ds_read_b64_tr_b16 v[220:221], v250 offset:128
  v_mfma_f32_16x16x32_bf16 v[28:31], v[232:235], v[156:159], v[28:31]
  ds_read_b64_tr_b16 v[222:223], v250 offset:640
  v_mfma_f32_16x16x32_bf16 v[32:35], v[232:235], v[160:163], v[32:35]
  ds_read_b64_tr_b16 v[224:225], v252 offset:24736
  v_mfma_f32_16x16x32_bf16 v[32:35], v[236:239], v[172:175], v[32:35]
  ds_read_b64_tr_b16 v[226:227], v252 offset:25248
  s_waitcnt lgkmcnt(6)
  v_mfma_f32_16x16x32_bf16 v[44:47], v[244:247], v[172:175], v[44:47]
  ds_read_b64_tr_b16 v[228:229], v250 offset:160
  v_mfma_f32_16x16x32_bf16 v[44:47], v[240:243], v[160:163], v[44:47]
  ds_read_b64_tr_b16 v[230:231], v250 offset:672
  v_mfma_f32_16x16x32_bf16 v[40:43], v[240:243], v[156:159], v[40:43]
  v_mfma_f32_16x16x32_bf16 v[40:43], v[244:247], v[168:171], v[40:43]
  v_mfma_f32_16x16x32_bf16 v[36:39], v[244:247], v[164:167], v[36:39]
  v_mfma_f32_16x16x32_bf16 v[36:39], v[240:243], v[152:155], v[36:39]
  s_waitcnt lgkmcnt(4)
  v_mfma_f32_16x16x32_bf16 v[48:51], v[216:219], v[152:155], v[48:51]
  ds_read_b64_tr_b16 v[232:233], v252 offset:24768
  v_mfma_f32_16x16x32_bf16 v[48:51], v[220:223], v[164:167], v[48:51]
  ds_read_b64_tr_b16 v[234:235], v252 offset:25280
  v_mfma_f32_16x16x32_bf16 v[52:55], v[220:223], v[168:171], v[52:55]
  ds_read_b64_tr_b16 v[236:237], v250 offset:192
  v_mfma_f32_16x16x32_bf16 v[52:55], v[216:219], v[156:159], v[52:55]
  ds_read_b64_tr_b16 v[238:239], v250 offset:704
  v_mfma_f32_16x16x32_bf16 v[56:59], v[216:219], v[160:163], v[56:59]
  ds_read_b64_tr_b16 v[240:241], v252 offset:24800
  v_mfma_f32_16x16x32_bf16 v[56:59], v[220:223], v[172:175], v[56:59]
  ds_read_b64_tr_b16 v[242:243], v252 offset:25312
  s_waitcnt lgkmcnt(6)
  v_mfma_f32_16x16x32_bf16 v[68:71], v[228:231], v[172:175], v[68:71]
  ds_read_b64_tr_b16 v[244:245], v250 offset:224
  v_mfma_f32_16x16x32_bf16 v[68:71], v[224:227], v[160:163], v[68:71]
  ds_read_b64_tr_b16 v[246:247], v250 offset:736
  v_mfma_f32_16x16x32_bf16 v[64:67], v[224:227], v[156:159], v[64:67]
  v_mfma_f32_16x16x32_bf16 v[64:67], v[228:231], v[168:171], v[64:67]
  v_add_u32 v252, s45, v252
  v_mfma_f32_16x16x32_bf16 v[60:63], v[228:231], v[164:167], v[60:63]
  v_add_u32 v250, s57, v250
  v_mfma_f32_16x16x32_bf16 v[60:63], v[224:227], v[152:155], v[60:63]
  s_waitcnt lgkmcnt(0)
  v_mfma_f32_16x16x32_bf16 v[72:75], v[232:235], v[152:155], v[72:75]
  s_barrier
  ds_read_b128 v[176:179], v248 offset:0
  ds_read_b128 v[188:191], v249 offset:0
  v_mfma_f32_16x16x32_bf16 v[72:75], v[236:239], v[164:167], v[72:75]
  ds_read_b64_tr_b16 v[216:217], v252 offset:24576
  v_mfma_f32_16x16x32_bf16 v[76:79], v[236:239], v[168:171], v[76:79]
  ds_read_b64_tr_b16 v[218:219], v252 offset:25088
  ds_read_b64_tr_b16 v[220:221], v250 offset:0
  v_mfma_f32_16x16x32_bf16 v[76:79], v[232:235], v[156:159], v[76:79]
  ds_read_b64_tr_b16 v[222:223], v250 offset:512
  v_mfma_f32_16x16x32_bf16 v[80:83], v[232:235], v[160:163], v[80:83]
  ds_read_b128 v[180:183], v248 offset:2048
  v_mfma_f32_16x16x32_bf16 v[80:83], v[236:239], v[172:175], v[80:83]
  ds_read_b128 v[192:195], v249 offset:2048
  ds_read_b128 v[184:187], v248 offset:4096
  v_mfma_f32_16x16x32_bf16 v[92:95], v[244:247], v[172:175], v[92:95]
  ds_read_b128 v[196:199], v249 offset:4096
  v_mfma_f32_16x16x32_bf16 v[92:95], v[240:243], v[160:163], v[92:95]
  ds_read_b64_tr_b16 v[224:225], v252 offset:24608
  ds_read_b64_tr_b16 v[226:227], v252 offset:25120
  v_mfma_f32_16x16x32_bf16 v[88:91], v[240:243], v[156:159], v[88:91]
  ds_read_b64_tr_b16 v[228:229], v250 offset:32
  v_mfma_f32_16x16x32_bf16 v[88:91], v[244:247], v[168:171], v[88:91]
  ds_read_b64_tr_b16 v[230:231], v250 offset:544
  v_mfma_f32_16x16x32_bf16 v[84:87], v[244:247], v[164:167], v[84:87]
  v_mfma_f32_16x16x32_bf16 v[84:87], v[240:243], v[152:155], v[84:87]
  s_waitcnt lgkmcnt(8)
  v_mfma_f32_16x16x32_bf16 v[0:3], v[216:219], v[176:179], v[0:3]
  ds_read_b64_tr_b16 v[232:233], v252 offset:24640
  v_mfma_f32_16x16x32_bf16 v[0:3], v[220:223], v[188:191], v[0:3]
  ds_read_b64_tr_b16 v[234:235], v252 offset:25152
  s_cmp_eq_u32 s52, 0
  s_waitcnt lgkmcnt(8)
  v_mfma_f32_16x16x32_bf16 v[4:7], v[220:223], v[192:195], v[4:7]
  ds_read_b64_tr_b16 v[236:237], v250 offset:64
  s_cselect_b32 s45, 0xfffef800, s46
  v_mfma_f32_16x16x32_bf16 v[4:7], v[216:219], v[180:183], v[4:7]
  ds_read_b64_tr_b16 v[238:239], v250 offset:576
  s_waitcnt lgkmcnt(8)
  v_mfma_f32_16x16x32_bf16 v[8:11], v[216:219], v[184:187], v[8:11]
  ds_read_b64_tr_b16 v[240:241], v252 offset:24672
  v_add_u32 v248, s45, v248
  v_mfma_f32_16x16x32_bf16 v[8:11], v[220:223], v[196:199], v[8:11]
  ds_read_b64_tr_b16 v[242:243], v252 offset:25184
  v_add_u32 v249, s45, v249
  s_waitcnt lgkmcnt(6)
  v_mfma_f32_16x16x32_bf16 v[20:23], v[228:231], v[196:199], v[20:23]
  ds_read_b64_tr_b16 v[244:245], v250 offset:96
  v_mfma_f32_16x16x32_bf16 v[20:23], v[224:227], v[184:187], v[20:23]
  ds_read_b64_tr_b16 v[246:247], v250 offset:608
  s_add_u32 s52, s52, 1
  v_mfma_f32_16x16x32_bf16 v[16:19], v[224:227], v[180:183], v[16:19]
  s_cmp_eq_u32 s52, 3
  v_mfma_f32_16x16x32_bf16 v[16:19], v[228:231], v[192:195], v[16:19]
  s_cselect_b32 s52, 0, s52
  v_mfma_f32_16x16x32_bf16 v[12:15], v[228:231], v[188:191], v[12:15]
  s_cselect_b32 s57, 0xffffbe00, s51
  v_mfma_f32_16x16x32_bf16 v[12:15], v[224:227], v[176:179], v[12:15]
  s_waitcnt lgkmcnt(4)
  v_mfma_f32_16x16x32_bf16 v[24:27], v[232:235], v[176:179], v[24:27]
  ds_read_b64_tr_b16 v[216:217], v252 offset:24704
  v_mfma_f32_16x16x32_bf16 v[24:27], v[236:239], v[188:191], v[24:27]
  ds_read_b64_tr_b16 v[218:219], v252 offset:25216
  v_mfma_f32_16x16x32_bf16 v[28:31], v[236:239], v[192:195], v[28:31]
  ds_read_b64_tr_b16 v[220:221], v250 offset:128
  v_mfma_f32_16x16x32_bf16 v[28:31], v[232:235], v[180:183], v[28:31]
  ds_read_b64_tr_b16 v[222:223], v250 offset:640
  v_mfma_f32_16x16x32_bf16 v[32:35], v[232:235], v[184:187], v[32:35]
  ds_read_b64_tr_b16 v[224:225], v252 offset:24736
  v_mfma_f32_16x16x32_bf16 v[32:35], v[236:239], v[196:199], v[32:35]
  ds_read_b64_tr_b16 v[226:227], v252 offset:25248
  s_waitcnt lgkmcnt(6)
  v_mfma_f32_16x16x32_bf16 v[44:47], v[244:247], v[196:199], v[44:47]
  ds_read_b64_tr_b16 v[228:229], v250 offset:160
  v_mfma_f32_16x16x32_bf16 v[44:47], v[240:243], v[184:187], v[44:47]
  ds_read_b64_tr_b16 v[230:231], v250 offset:672
  v_mfma_f32_16x16x32_bf16 v[40:43], v[240:243], v[180:183], v[40:43]
  v_mfma_f32_16x16x32_bf16 v[40:43], v[244:247], v[192:195], v[40:43]
  v_mfma_f32_16x16x32_bf16 v[36:39], v[244:247], v[188:191], v[36:39]
  v_mfma_f32_16x16x32_bf16 v[36:39], v[240:243], v[176:179], v[36:39]
  s_waitcnt lgkmcnt(4)
  v_mfma_f32_16x16x32_bf16 v[48:51], v[216:219], v[176:179], v[48:51]
  ds_read_b64_tr_b16 v[232:233], v252 offset:24768
  v_mfma_f32_16x16x32_bf16 v[48:51], v[220:223], v[188:191], v[48:51]
  ds_read_b64_tr_b16 v[234:235], v252 offset:25280
  v_mfma_f32_16x16x32_bf16 v[52:55], v[220:223], v[192:195], v[52:55]
  ds_read_b64_tr_b16 v[236:237], v250 offset:192
  v_mfma_f32_16x16x32_bf16 v[52:55], v[216:219], v[180:183], v[52:55]
  ds_read_b64_tr_b16 v[238:239], v250 offset:704
  v_mfma_f32_16x16x32_bf16 v[56:59], v[216:219], v[184:187], v[56:59]
  ds_read_b64_tr_b16 v[240:241], v252 offset:24800
  v_mfma_f32_16x16x32_bf16 v[56:59], v[220:223], v[196:199], v[56:59]
  ds_read_b64_tr_b16 v[242:243], v252 offset:25312
  s_waitcnt lgkmcnt(6)
  v_mfma_f32_16x16x32_bf16 v[68:71], v[228:231], v[196:199], v[68:71]
  ds_read_b64_tr_b16 v[244:245], v250 offset:224
  v_mfma_f32_16x16x32_bf16 v[68:71], v[224:227], v[184:187], v[68:71]
  ds_read_b64_tr_b16 v[246:247], v250 offset:736
  v_mfma_f32_16x16x32_bf16 v[64:67], v[224:227], v[180:183], v[64:67]
  s_add_u32 s44, s44, 1
  v_mfma_f32_16x16x32_bf16 v[64:67], v[228:231], v[192:195], v[64:67]
  v_add_u32 v252, s45, v252
  v_mfma_f32_16x16x32_bf16 v[60:63], v[228:231], v[188:191], v[60:63]
  v_add_u32 v250, s57, v250
  v_mfma_f32_16x16x32_bf16 v[60:63], v[224:227], v[176:179], v[60:63]
  s_cmp_lt_u32 s44, 4
  s_waitcnt lgkmcnt(0)
  v_mfma_f32_16x16x32_bf16 v[72:75], v[232:235], v[176:179], v[72:75]
  s_barrier
  ds_read_b128 v[152:155], v248 offset:0
  ds_read_b128 v[164:167], v249 offset:0
  v_mfma_f32_16x16x32_bf16 v[72:75], v[236:239], v[188:191], v[72:75]
  ds_read_b64_tr_b16 v[216:217], v252 offset:24576
  v_mfma_f32_16x16x32_bf16 v[76:79], v[236:239], v[192:195], v[76:79]
  ds_read_b64_tr_b16 v[218:219], v252 offset:25088
  ds_read_b64_tr_b16 v[220:221], v250 offset:0
  v_mfma_f32_16x16x32_bf16 v[76:79], v[232:235], v[180:183], v[76:79]
  ds_read_b64_tr_b16 v[222:223], v250 offset:512
  v_mfma_f32_16x16x32_bf16 v[80:83], v[232:235], v[184:187], v[80:83]
  ds_read_b128 v[156:159], v248 offset:2048
  v_mfma_f32_16x16x32_bf16 v[80:83], v[236:239], v[196:199], v[80:83]
  ds_read_b128 v[168:171], v249 offset:2048
  ds_read_b128 v[160:163], v248 offset:4096
  v_mfma_f32_16x16x32_bf16 v[92:95], v[244:247], v[196:199], v[92:95]
  ds_read_b128 v[172:175], v249 offset:4096
  v_mfma_f32_16x16x32_bf16 v[92:95], v[240:243], v[184:187], v[92:95]
  ds_read_b64_tr_b16 v[224:225], v252 offset:24608
  ds_read_b64_tr_b16 v[226:227], v252 offset:25120
  v_mfma_f32_16x16x32_bf16 v[88:91], v[240:243], v[180:183], v[88:91]
  ds_read_b64_tr_b16 v[228:229], v250 offset:32
  v_mfma_f32_16x16x32_bf16 v[88:91], v[244:247], v[192:195], v[88:91]
  ds_read_b64_tr_b16 v[230:231], v250 offset:544
  v_mfma_f32_16x16x32_bf16 v[84:87], v[244:247], v[188:191], v[84:87]
  v_mfma_f32_16x16x32_bf16 v[84:87], v[240:243], v[176:179], v[84:87]
  s_cbranch_scc1 L_qloop
  s_waitcnt vmcnt(0)
  s_waitcnt lgkmcnt(8)
  v_mfma_f32_16x16x32_bf16 v[0:3], v[216:219], v[152:155], v[0:3]
  ds_read_b64_tr_b16 v[232:233], v252 offset:24640
  v_mfma_f32_16x16x32_bf16 v[0:3], v[220:223], v[164:167], v[0:3]
  ds_read_b64_tr_b16 v[234:235], v252 offset:25152
  s_cmp_eq_u32 s52, 0
  s_waitcnt lgkmcnt(8)
  v_mfma_f32_16x16x32_bf16 v[4:7], v[220:223], v[168:171], v[4:7]
  ds_read_b64_tr_b16 v[236:237], v250 offset:64
  s_cselect_b32 s45, 0xfffef800, s46
  v_mfma_f32_16x16x32_bf16 v[4:7], v[216:219], v[156:159], v[4:7]
  ds_read_b64_tr_b16 v[238:239], v250 offset:576
  s_waitcnt lgkmcnt(8)
  v_mfma_f32_16x16x32_bf16 v[8:11], v[216:219], v[160:163], v[8:11]
  ds_read_b64_tr_b16 v[240:241], v252 offset:24672
  v_add_u32 v248, s45, v248
  v_mfma_f32_16x16x32_bf16 v[8:11], v[220:223], v[172:175], v[8:11]
  ds_read_b64_tr_b16 v[242:243], v252 offset:25184
  v_add_u32 v249, s45, v249
  s_waitcnt lgkmcnt(6)
  v_mfma_f32_16x16x32_bf16 v[20:23], v[228:231], v[172:175], v[20:23]
  ds_read_b64_tr_b16 v[244:245], v250 offset:96
  v_mfma_f32_16x16x32_bf16 v[20:23], v[224:227], v[160:163], v[20:23]
  ds_read_b64_tr_b16 v[246:247], v250 offset:608
  s_add_u32 s52, s52, 1
  v_mfma_f32_16x16x32_bf16 v[16:19], v[224:227], v[156:159], v[16:19]
  s_cmp_eq_u32 s52, 3
  v_mfma_f32_16x16x32_bf16 v[16:19], v[228:231], v[168:171], v[16:19]
  s_cselect_b32 s52, 0, s52
  v_mfma_f32_16x16x32_bf16 v[12:15], v[228:231], v[164:167], v[12:15]
  s_cselect_b32 s57, 0xffffbe00, s51
  v_mfma_f32_16x16x32_bf16 v[12:15], v[224:227], v[152:155], v[12:15]
  s_waitcnt lgkmcnt(4)
  v_mfma_f32_16x16x32_bf16 v[24:27], v[232:235], v[152:155], v[24:27]
  ds_read_b64_tr_b16 v[216:217], v252 offset:24704
  v_mfma_f32_16x16x32_bf16 v[24:27], v[236:239], v[164:167], v[24:27]
  ds_read_b64_tr_b16 v[218:219], v252 offset:25216
  v_mfma_f32_16x16x32_bf16 v[28:31], v[236:239], v[168:171], v[28:31]
  ds_read_b64_tr_b16 v[220:221], v250 offset:128
  v_mfma_f32_16x16x32_bf16 v[28:31], v[232:235], v[156:159], v[28:31]
  ds_read_b64_tr_b16 v[222:223], v250 offset:640
  v_mfma_f32_16x16x32_bf16 v[32:35], v[232:235], v[160:163], v[32:35]
  ds_read_b64_tr_b16 v[224:225], v252 offset:24736
  v_mfma_f32_16x16x32_bf16 v[32:35], v[236:239], v[172:175], v[32:35]
  ds_read_b64_tr_b16 v[226:227], v252 offset:25248
  s_waitcnt lgkmcnt(6)
  v_mfma_f32_16x16x32_bf16 v[44:47], v[244:247], v[172:175], v[44:47]
  ds_read_b64_tr_b16 v[228:229], v250 offset:160
  v_mfma_f32_16x16x32_bf16 v[44:47], v[240:243], v[160:163], v[44:47]
  ds_read_b64_tr_b16 v[230:231], v250 offset:672
  v_mfma_f32_16x16x32_bf16 v[40:43], v[240:243], v[156:159], v[40:43]
  v_mfma_f32_16x16x32_bf16 v[40:43], v[244:247], v[168:171], v[40:43]
  v_mfma_f32_16x16x32_bf16 v[36:39], v[244:247], v[164:167], v[36:39]
  v_mfma_f32_16x16x32_bf16 v[36:39], v[240:243], v[152:155], v[36:39]
  s_waitcnt lgkmcnt(4)
  v_mfma_f32_16x16x32_bf16 v[48:51], v[216:219], v[152:155], v[48:51]
  ds_read_b64_tr_b16 v[232:233], v252 offset:24768
  v_mfma_f32_16x16x32_bf16 v[48:51], v[220:223], v[164:167], v[48:51]
  ds_read_b64_tr_b16 v[234:235], v252 offset:25280
  v_mfma_f32_16x16x32_bf16 v[52:55], v[220:223], v[168:171], v[52:55]
  ds_read_b64_tr_b16 v[236:237], v250 offset:192
  v_mfma_f32_16x16x32_bf16 v[52:55], v[216:219], v[156:159], v[52:55]
  ds_read_b64_tr_b16 v[238:239], v250 offset:704
  v_mfma_f32_16x16x32_bf16 v[56:59], v[216:219], v[160:163], v[56:59]
  ds_read_b64_tr_b16 v[240:241], v252 offset:24800
  v_mfma_f32_16x16x32_bf16 v[56:59], v[220:223], v[172:175], v[56:59]
  ds_read_b64_tr_b16 v[242:243], v252 offset:25312
  s_waitcnt lgkmcnt(6)
  v_mfma_f32_16x16x32_bf16 v[68:71], v[228:231], v[172:175], v[68:71]
  ds_read_b64_tr_b16 v[244:245], v250 offset:224
  v_mfma_f32_16x16x32_bf16 v[68:71], v[224:227], v[160:163], v[68:71]
  ds_read_b64_tr_b16 v[246:247], v250 offset:736
  v_mfma_f32_16x16x32_bf16 v[64:67], v[224:227], v[156:159], v[64:67]
  v_mfma_f32_16x16x32_bf16 v[64:67], v[228:231], v[168:171], v[64:67]
  v_add_u32 v252, s45, v252
  v_mfma_f32_16x16x32_bf16 v[60:63], v[228:231], v[164:167], v[60:63]
  v_add_u32 v250, s57, v250
  v_mfma_f32_16x16x32_bf16 v[60:63], v[224:227], v[152:155], v[60:63]
  s_waitcnt lgkmcnt(0)
  v_mfma_f32_16x16x32_bf16 v[72:75], v[232:235], v[152:155], v[72:75]
  s_barrier
  ds_read_b128 v[176:179], v248 offset:0
  ds_read_b128 v[188:191], v249 offset:0
  v_mfma_f32_16x16x32_bf16 v[72:75], v[236:239], v[164:167], v[72:75]
  ds_read_b64_tr_b16 v[216:217], v252 offset:24576
  v_mfma_f32_16x16x32_bf16 v[76:79], v[236:239], v[168:171], v[76:79]
  ds_read_b64_tr_b16 v[218:219], v252 offset:25088
  ds_read_b64_tr_b16 v[220:221], v250 offset:0
  v_mfma_f32_16x16x32_bf16 v[76:79], v[232:235], v[156:159], v[76:79]
  ds_read_b64_tr_b16 v[222:223], v250 offset:512
  v_mfma_f32_16x16x32_bf16 v[80:83], v[232:235], v[160:163], v[80:83]
  ds_read_b128 v[180:183], v248 offset:2048
  v_mfma_f32_16x16x32_bf16 v[80:83], v[236:239], v[172:175], v[80:83]
  ds_read_b128 v[192:195], v249 offset:2048
  ds_read_b128 v[184:187], v248 offset:4096
  v_mfma_f32_16x16x32_bf16 v[92:95], v[244:247], v[172:175], v[92:95]
  ds_read_b128 v[196:199], v249 offset:4096
  v_mfma_f32_16x16x32_bf16 v[92:95], v[240:243], v[160:163], v[92:95]
  ds_read_b64_tr_b16 v[224:225], v252 offset:24608
  ds_read_b64_tr_b16 v[226:227], v252 offset:25120
  v_mfma_f32_16x16x32_bf16 v[88:91], v[240:243], v[156:159], v[88:91]
  ds_read_b64_tr_b16 v[228:229], v250 offset:32
  v_mfma_f32_16x16x32_bf16 v[88:91], v[244:247], v[168:171], v[88:91]
  ds_read_b64_tr_b16 v[230:231], v250 offset:544
  v_mfma_f32_16x16x32_bf16 v[84:87], v[244:247], v[164:167], v[84:87]
  v_mfma_f32_16x16x32_bf16 v[84:87], v[240:243], v[152:155], v[84:87]
  s_waitcnt lgkmcnt(8)
  v_mfma_f32_16x16x32_bf16 v[0:3], v[216:219], v[176:179], v[0:3]
  ds_read_b64_tr_b16 v[232:233], v252 offset:24640
  v_mfma_f32_16x16x32_bf16 v[0:3], v[220:223], v[188:191], v[0:3]
  ds_read_b64_tr_b16 v[234:235], v252 offset:25152
  s_waitcnt lgkmcnt(8)
  v_mfma_f32_16x16x32_bf16 v[4:7], v[220:223], v[192:195], v[4:7]
  ds_read_b64_tr_b16 v[236:237], v250 offset:64
  v_mfma_f32_16x16x32_bf16 v[4:7], v[216:219], v[180:183], v[4:7]
  ds_read_b64_tr_b16 v[238:239], v250 offset:576
  s_waitcnt lgkmcnt(8)
  v_mfma_f32_16x16x32_bf16 v[8:11], v[216:219], v[184:187], v[8:11]
  ds_read_b64_tr_b16 v[240:241], v252 offset:24672
  v_mfma_f32_16x16x32_bf16 v[8:11], v[220:223], v[196:199], v[8:11]
  ds_read_b64_tr_b16 v[242:243], v252 offset:25184
  s_waitcnt lgkmcnt(6)
  v_mfma_f32_16x16x32_bf16 v[20:23], v[228:231], v[196:199], v[20:23]
  ds_read_b64_tr_b16 v[244:245], v250 offset:96
  v_mfma_f32_16x16x32_bf16 v[20:23], v[224:227], v[184:187], v[20:23]
  ds_read_b64_tr_b16 v[246:247], v250 offset:608
  v_mfma_f32_16x16x32_bf16 v[16:19], v[224:227], v[180:183], v[16:19]
  v_mfma_f32_16x16x32_bf16 v[16:19], v[228:231], v[192:195], v[16:19]
  v_mfma_f32_16x16x32_bf16 v[12:15], v[228:231], v[188:191], v[12:15]
  v_mfma_f32_16x16x32_bf16 v[12:15], v[224:227], v[176:179], v[12:15]
  s_waitcnt lgkmcnt(4)
  v_mfma_f32_16x16x32_bf16 v[24:27], v[232:235], v[176:179], v[24:27]
  ds_read_b64_tr_b16 v[216:217], v252 offset:24704
  v_mfma_f32_16x16x32_bf16 v[24:27], v[236:239], v[188:191], v[24:27]
  ds_read_b64_tr_b16 v[218:219], v252 offset:25216
  v_mfma_f32_16x16x32_bf16 v[28:31], v[236:239], v[192:195], v[28:31]
  ds_read_b64_tr_b16 v[220:221], v250 offset:128
  v_mfma_f32_16x16x32_bf16 v[28:31], v[232:235], v[180:183], v[28:31]
  ds_read_b64_tr_b16 v[222:223], v250 offset:640
  v_mfma_f32_16x16x32_bf16 v[32:35], v[232:235], v[184:187], v[32:35]
  ds_read_b64_tr_b16 v[224:225], v252 offset:24736
  v_mfma_f32_16x16x32_bf16 v[32:35], v[236:239], v[196:199], v[32:35]
  ds_read_b64_tr_b16 v[226:227], v252 offset:25248
  v_pk_mul_f32 v[0:1], v[0:1], s[58:59]
  v_pk_mul_f32 v[2:3], v[2:3], s[58:59]
  v_pk_mul_f32 v[12:13], v[12:13], s[58:59]
  v_pk_mul_f32 v[14:15], v[14:15], s[58:59]
  v_cvt_pk_bf16_f32 v96, v0, v1
  v_cvt_pk_bf16_f32 v97, v2, v3
  v_cvt_pk_bf16_f32 v98, v12, v13
  s_waitcnt lgkmcnt(6)
  v_mfma_f32_16x16x32_bf16 v[44:47], v[244:247], v[196:199], v[44:47]
  ds_read_b64_tr_b16 v[228:229], v250 offset:160
  v_cvt_pk_bf16_f32 v99, v14, v15
  v_mov_b64 v[0:1], 0
  v_mov_b64 v[2:3], 0
  v_mov_b64 v[12:13], 0
  v_mov_b64 v[14:15], 0
  v_pk_mul_f32 v[4:5], v[4:5], s[58:59]
  v_pk_mul_f32 v[6:7], v[6:7], s[58:59]
  v_mfma_f32_16x16x32_bf16 v[44:47], v[240:243], v[184:187], v[44:47]
  ds_read_b64_tr_b16 v[230:231], v250 offset:672
  v_pk_mul_f32 v[16:17], v[16:17], s[58:59]
  v_pk_mul_f32 v[18:19], v[18:19], s[58:59]
  v_cvt_pk_bf16_f32 v112, v4, v5
  v_cvt_pk_bf16_f32 v113, v6, v7
  v_cvt_pk_bf16_f32 v114, v16, v17
  v_cvt_pk_bf16_f32 v115, v18, v19
  v_mov_b64 v[4:5], 0
  v_mfma_f32_16x16x32_bf16 v[40:43], v[240:243], v[180:183], v[40:43]
  v_mov_b64 v[6:7], 0
  v_mov_b64 v[16:17], 0
  v_mov_b64 v[18:19], 0
  v_pk_mul_f32 v[8:9], v[8:9], s[58:59]
  v_pk_mul_f32 v[10:11], v[10:11], s[58:59]
  v_pk_mul_f32 v[20:21], v[20:21], s[58:59]
  v_pk_mul_f32 v[22:23], v[22:23], s[58:59]
  v_mfma_f32_16x16x32_bf16 v[40:43], v[244:247], v[192:195], v[40:43]
  v_cvt_pk_bf16_f32 v128, v8, v9
  v_cvt_pk_bf16_f32 v129, v10, v11
  v_cvt_pk_bf16_f32 v130, v20, v21
  v_cvt_pk_bf16_f32 v131, v22, v23
  v_mov_b64 v[8:9], 0
  v_mov_b64 v[10:11], 0
  v_mov_b64 v[20:21], 0
  v_mfma_f32_16x16x32_bf16 v[36:39], v[244:247], v[188:191], v[36:39]
  v_mov_b64 v[22:23], 0
  v_permlane32_swap_b32 v96, v98
  v_permlane32_swap_b32 v97, v99
  v_permlane32_swap_b32 v112, v114
  v_permlane32_swap_b32 v113, v115
  v_permlane32_swap_b32 v128, v130
  v_permlane32_swap_b32 v129, v131
  v_mfma_f32_16x16x32_bf16 v[36:39], v[240:243], v[176:179], v[36:39]
  v_permlane16_swap_b32 v96, v98
  v_permlane16_swap_b32 v97, v99
  v_permlane16_swap_b32 v112, v114
  v_permlane16_swap_b32 v113, v115
  v_permlane16_swap_b32 v128, v130
  v_permlane16_swap_b32 v129, v131
  s_waitcnt lgkmcnt(4)
  v_mfma_f32_16x16x32_bf16 v[48:51], v[216:219], v[176:179], v[48:51]
  ds_read_b64_tr_b16 v[232:233], v252 offset:24768
  v_mfma_f32_16x16x32_bf16 v[48:51], v[220:223], v[188:191], v[48:51]
  ds_read_b64_tr_b16 v[234:235], v252 offset:25280
  v_mfma_f32_16x16x32_bf16 v[52:55], v[220:223], v[192:195], v[52:55]
  ds_read_b64_tr_b16 v[236:237], v250 offset:192
  v_mfma_f32_16x16x32_bf16 v[52:55], v[216:219], v[180:183], v[52:55]
  ds_read_b64_tr_b16 v[238:239], v250 offset:704
  v_mfma_f32_16x16x32_bf16 v[56:59], v[216:219], v[184:187], v[56:59]
  ds_read_b64_tr_b16 v[240:241], v252 offset:24800
  v_mfma_f32_16x16x32_bf16 v[56:59], v[220:223], v[196:199], v[56:59]
  ds_read_b64_tr_b16 v[242:243], v252 offset:25312
  v_pk_mul_f32 v[24:25], v[24:25], s[58:59]
  v_pk_mul_f32 v[26:27], v[26:27], s[58:59]
  v_pk_mul_f32 v[36:37], v[36:37], s[58:59]
  v_pk_mul_f32 v[38:39], v[38:39], s[58:59]
  v_cvt_pk_bf16_f32 v100, v24, v25
  v_cvt_pk_bf16_f32 v101, v26, v27
  v_cvt_pk_bf16_f32 v102, v36, v37
  s_waitcnt lgkmcnt(6)
  v_mfma_f32_16x16x32_bf16 v[68:71], v[228:231], v[196:199], v[68:71]
  ds_read_b64_tr_b16 v[244:245], v250 offset:224
  v_cvt_pk_bf16_f32 v103, v38, v39
  v_mov_b64 v[24:25], 0
  v_mov_b64 v[26:27], 0
  v_mov_b64 v[36:37], 0
  v_mov_b64 v[38:39], 0
  v_pk_mul_f32 v[28:29], v[28:29], s[58:59]
  v_pk_mul_f32 v[30:31], v[30:31], s[58:59]
  v_mfma_f32_16x16x32_bf16 v[68:71], v[224:227], v[184:187], v[68:71]
  ds_read_b64_tr_b16 v[246:247], v250 offset:736
  v_pk_mul_f32 v[40:41], v[40:41], s[58:59]
  v_pk_mul_f32 v[42:43], v[42:43], s[58:59]
  v_cvt_pk_bf16_f32 v116, v28, v29
  v_cvt_pk_bf16_f32 v117, v30, v31
  v_cvt_pk_bf16_f32 v118, v40, v41
  v_cvt_pk_bf16_f32 v119, v42, v43
  v_mov_b64 v[28:29], 0
  v_mfma_f32_16x16x32_bf16 v[64:67], v[224:227], v[180:183], v[64:67]
  v_mov_b64 v[30:31], 0
  v_mov_b64 v[40:41], 0
  v_mov_b64 v[42:43], 0
  v_pk_mul_f32 v[32:33], v[32:33], s[58:59]
  v_pk_mul_f32 v[34:35], v[34:35], s[58:59]
  v_pk_mul_f32 v[44:45], v[44:45], s[58:59]
  v_pk_mul_f32 v[46:47], v[46:47], s[58:59]
  v_mfma_f32_16x16x32_bf16 v[64:67], v[228:231], v[192:195], v[64:67]
  v_cvt_pk_bf16_f32 v132, v32, v33
  v_cvt_pk_bf16_f32 v133, v34, v35
  v_cvt_pk_bf16_f32 v134, v44, v45
  v_cvt_pk_bf16_f32 v135, v46, v47
  v_mov_b64 v[32:33], 0
  v_mov_b64 v[34:35], 0
  v_mov_b64 v[44:45], 0
  v_mfma_f32_16x16x32_bf16 v[60:63], v[228:231], v[188:191], v[60:63]
  v_mov_b64 v[46:47], 0
  v_permlane32_swap_b32 v100, v102
  v_permlane32_swap_b32 v101, v103
  v_permlane32_swap_b32 v116, v118
  v_permlane32_swap_b32 v117, v119
  v_permlane32_swap_b32 v132, v134
  v_permlane32_swap_b32 v133, v135
  v_mfma_f32_16x16x32_bf16 v[60:63], v[224:227], v[176:179], v[60:63]
  v_permlane16_swap_b32 v100, v102
  v_permlane16_swap_b32 v101, v103
  v_permlane16_swap_b32 v116, v118
  v_permlane16_swap_b32 v117, v119
  v_permlane16_swap_b32 v132, v134
  v_permlane16_swap_b32 v133, v135
  s_waitcnt lgkmcnt(0)
  v_mfma_f32_16x16x32_bf16 v[72:75], v[232:235], v[176:179], v[72:75]
  s_barrier
  v_mfma_f32_16x16x32_bf16 v[72:75], v[236:239], v[188:191], v[72:75]
  v_mfma_f32_16x16x32_bf16 v[76:79], v[236:239], v[192:195], v[76:79]
  v_mfma_f32_16x16x32_bf16 v[76:79], v[232:235], v[180:183], v[76:79]
  v_mfma_f32_16x16x32_bf16 v[80:83], v[232:235], v[184:187], v[80:83]
  v_mfma_f32_16x16x32_bf16 v[80:83], v[236:239], v[196:199], v[80:83]
  v_pk_mul_f32 v[48:49], v[48:49], s[58:59]
  v_pk_mul_f32 v[50:51], v[50:51], s[58:59]
  v_pk_mul_f32 v[60:61], v[60:61], s[58:59]
  v_pk_mul_f32 v[62:63], v[62:63], s[58:59]
  v_cvt_pk_bf16_f32 v104, v48, v49
  v_cvt_pk_bf16_f32 v105, v50, v51
  v_cvt_pk_bf16_f32 v106, v60, v61
  v_mfma_f32_16x16x32_bf16 v[92:95], v[244:247], v[196:199], v[92:95]
  v_cvt_pk_bf16_f32 v107, v62, v63
  v_mov_b64 v[48:49], 0
  v_mov_b64 v[50:51], 0
  v_mov_b64 v[60:61], 0
  v_mov_b64 v[62:63], 0
  v_pk_mul_f32 v[52:53], v[52:53], s[58:59]
  v_pk_mul_f32 v[54:55], v[54:55], s[58:59]
  v_mfma_f32_16x16x32_bf16 v[92:95], v[240:243], v[184:187], v[92:95]
  v_pk_mul_f32 v[64:65], v[64:65], s[58:59]
  v_pk_mul_f32 v[66:67], v[66:67], s[58:59]
  v_cvt_pk_bf16_f32 v120, v52, v53
  v_cvt_pk_bf16_f32 v121, v54, v55
  v_cvt_pk_bf16_f32 v122, v64, v65
  v_cvt_pk_bf16_f32 v123, v66, v67
  v_mov_b64 v[52:53], 0
  v_mfma_f32_16x16x32_bf16 v[88:91], v[240:243], v[180:183], v[88:91]
  v_mov_b64 v[54:55], 0
  v_mov_b64 v[64:65], 0
  v_mov_b64 v[66:67], 0
  v_pk_mul_f32 v[56:57], v[56:57], s[58:59]
  v_pk_mul_f32 v[58:59], v[58:59], s[58:59]
  v_pk_mul_f32 v[68:69], v[68:69], s[58:59]
  v_pk_mul_f32 v[70:71], v[70:71], s[58:59]
  v_mfma_f32_16x16x32_bf16 v[88:91], v[244:247], v[192:195], v[88:91]
  v_cvt_pk_bf16_f32 v136, v56, v57
  v_cvt_pk_bf16_f32 v137, v58, v59
  v_cvt_pk_bf16_f32 v138, v68, v69
  v_cvt_pk_bf16_f32 v139, v70, v71
  v_mov_b64 v[56:57], 0
  v_mov_b64 v[58:59], 0
  v_mov_b64 v[68:69], 0
  v_mfma_f32_16x16x32_bf16 v[84:87], v[244:247], v[188:191], v[84:87]
  v_mov_b64 v[70:71], 0
  v_permlane32_swap_b32 v104, v106
  v_permlane32_swap_b32 v105, v107
  v_permlane32_swap_b32 v120, v122
  v_permlane32_swap_b32 v121, v123
  v_permlane32_swap_b32 v136, v138
  v_permlane32_swap_b32 v137, v139
  v_mfma_f32_16x16x32_bf16 v[84:87], v[240:243], v[176:179], v[84:87]
  v_permlane16_swap_b32 v104, v106
  v_permlane16_swap_b32 v105, v107
  v_permlane16_swap_b32 v120, v122
  v_permlane16_swap_b32 v121, v123
  v_permlane16_swap_b32 v136, v138
  v_permlane16_swap_b32 v137, v139
  s_waitcnt vmcnt(0)
  v_readfirstlane_b32 s86, v200
  v_readfirstlane_b32 s30, v201
  v_readfirstlane_b32 s31, v202
  s_nop 3
  v_pk_mul_f32 v[72:73], v[72:73], s[58:59]
  v_pk_mul_f32 v[74:75], v[74:75], s[58:59]
  v_pk_mul_f32 v[84:85], v[84:85], s[58:59]
  v_pk_mul_f32 v[86:87], v[86:87], s[58:59]
  v_cvt_pk_bf16_f32 v108, v72, v73
  v_cvt_pk_bf16_f32 v109, v74, v75
  v_cvt_pk_bf16_f32 v110, v84, v85
  v_cvt_pk_bf16_f32 v111, v86, v87
  v_mov_b64 v[72:73], 0
  v_mov_b64 v[74:75], 0
  v_mov_b64 v[84:85], 0
  v_mov_b64 v[86:87], 0
  v_pk_mul_f32 v[76:77], v[76:77], s[58:59]
  v_pk_mul_f32 v[78:79], v[78:79], s[58:59]
  v_pk_mul_f32 v[88:89], v[88:89], s[58:59]
  v_pk_mul_f32 v[90:91], v[90:91], s[58:59]
  v_cvt_pk_bf16_f32 v124, v76, v77
  v_cvt_pk_bf16_f32 v125, v78, v79
  v_cvt_pk_bf16_f32 v126, v88, v89
  v_cvt_pk_bf16_f32 v127, v90, v91
  v_mov_b64 v[76:77], 0
  v_mov_b64 v[78:79], 0
  v_mov_b64 v[88:89], 0
  v_mov_b64 v[90:91], 0
  v_pk_mul_f32 v[80:81], v[80:81], s[58:59]
  v_pk_mul_f32 v[82:83], v[82:83], s[58:59]
  v_pk_mul_f32 v[92:93], v[92:93], s[58:59]
  v_pk_mul_f32 v[94:95], v[94:95], s[58:59]
  v_cvt_pk_bf16_f32 v140, v80, v81
  v_cvt_pk_bf16_f32 v141, v82, v83
  v_cvt_pk_bf16_f32 v142, v92, v93
  v_cvt_pk_bf16_f32 v143, v94, v95
  v_mov_b64 v[80:81], 0
  v_mov_b64 v[82:83], 0
  v_mov_b64 v[92:93], 0
  v_mov_b64 v[94:95], 0
  v_permlane32_swap_b32 v108, v110
  v_permlane32_swap_b32 v109, v111
  v_permlane32_swap_b32 v124, v126
  v_permlane32_swap_b32 v125, v127
  v_permlane32_swap_b32 v140, v142
  v_permlane32_swap_b32 v141, v143
  v_permlane16_swap_b32 v108, v110
  v_permlane16_swap_b32 v109, v111
  v_permlane16_swap_b32 v124, v126
  v_permlane16_swap_b32 v125, v127
  v_permlane16_swap_b32 v140, v142
  v_permlane16_swap_b32 v141, v143
  ds_read_addtid_b32 v255 offset:0
  v_mov_b32 v252, v254
  v_mov_b32 v144, 0
  v_mov_b32 v145, 0
  v_mov_b32 v146, 0
  v_mov_b32 v147, 0
  v_mov_b32 v148, 0
  v_mov_b32 v149, 0
  v_mov_b32 v150, 0
  v_mov_b32 v151, 0
  v_mov_b32 v152, 0
  v_mov_b32 v153, 0
  v_mov_b32 v154, 0
  v_mov_b32 v155, 0
  s_mov_b32 s44, 130
  s_mov_b32 s46, 33792
  s_mov_b32 s47, 0xfffe7400
  s_mov_b32 s25, s63
  s_mov_b32 s48, 0x3f803f80
  s_waitcnt lgkmcnt(0)
  v_cmp_gt_u32 vcc, 129, v255
  s_nop 1
  s_cbranch_vccnz L_spin_init
L_spun_init:
  s_waitcnt lgkmcnt(0)
  ds_read_b128 v[232:235], v252 offset:0
  ds_read_b128 v[236:239], v252 offset:64
  ds_read_b128 v[240:243], v252 offset:128
  ds_read_b128 v[244:247], v252 offset:192
  s_waitcnt lgkmcnt(0)
  v_mfma_f32_16x16x32_bf16 v[168:171], v[232:235], v[96:99], 0
  v_mfma_f32_16x16x32_bf16 v[168:171], v[236:239], v[100:103], v[168:171]
  v_mfma_f32_16x16x32_bf16 v[168:171], v[240:243], v[104:107], v[168:171]
  v_mfma_f32_16x16x32_bf16 v[168:171], v[244:247], v[108:111], v[168:171]
  v_mfma_f32_16x16x32_bf16 v[172:175], v[244:247], v[124:127], 0
  v_mfma_f32_16x16x32_bf16 v[172:175], v[240:243], v[120:123], v[172:175]
  v_mfma_f32_16x16x32_bf16 v[172:175], v[236:239], v[116:119], v[172:175]
  v_mfma_f32_16x16x32_bf16 v[172:175], v[232:235], v[112:115], v[172:175]
  v_mfma_f32_16x16x32_bf16 v[176:179], v[232:235], v[128:131], 0
  v_mfma_f32_16x16x32_bf16 v[176:179], v[236:239], v[132:135], v[176:179]
  v_mfma_f32_16x16x32_bf16 v[176:179], v[240:243], v[136:139], v[176:179]
  v_mfma_f32_16x16x32_bf16 v[176:179], v[244:247], v[140:143], v[176:179]
  ds_read_b128 v[216:219], v252 offset:0
  ds_read_b128 v[220:223], v252 offset:64
  ds_read_b128 v[224:227], v252 offset:128
  ds_read_b128 v[228:231], v252 offset:192
  s_nop 3
  v_max3_f32 v192, v168, v169, v170
  v_max_f32 v192, v192, v171
  v_max3_f32 v196, v172, v173, v174
  v_max_f32 v196, v196, v175
  v_max3_f32 v200, v176, v177, v178
  v_max_f32 v200, v200, v179
  v_mov_b32 v193, v192
  v_mov_b32 v197, v196
  v_mov_b32 v201, v200
  s_nop 1
  v_permlane32_swap_b32 v192, v193
  v_permlane32_swap_b32 v196, v197
  v_permlane32_swap_b32 v200, v201
  s_nop 1
  v_max_f32 v192, v192, v193
  v_max_f32 v196, v196, v197
  v_max_f32 v200, v200, v201
  v_mov_b32 v193, v192
  v_mov_b32 v197, v196
  v_mov_b32 v201, v200
  s_nop 1
  v_permlane16_swap_b32 v192, v193
  v_permlane16_swap_b32 v196, v197
  v_permlane16_swap_b32 v200, v201
  s_nop 1
  v_max_f32 v192, v192, v193
  v_max_f32 v196, v196, v197
  v_max_f32 v200, v200, v201
  v_add_f32 v192, 0x40e00000, v192
  v_mul_f32 v156, -1.0, v192
  v_mul_f32 v157, -1.0, v192
  v_mul_f32 v158, -1.0, v192
  v_mul_f32 v159, -1.0, v192
  v_add_f32 v196, 0x40e00000, v196
  v_mul_f32 v160, -1.0, v196
  v_mul_f32 v161, -1.0, v196
  v_mul_f32 v162, -1.0, v196
  v_mul_f32 v163, -1.0, v196
  v_add_f32 v200, 0x40e00000, v200
  v_mul_f32 v164, -1.0, v200
  v_mul_f32 v165, -1.0, v200
  v_mul_f32 v166, -1.0, v200
  v_mul_f32 v167, -1.0, v200
  s_nop 1
L_body:
  s_waitcnt lgkmcnt(0)
  v_mfma_f32_16x16x32_bf16 v[168:171], v[216:219], v[96:99], v[156:159]
  ds_read_b128 v[232:235], v252 offset:512
  v_mfma_f32_16x16x32_bf16 v[168:171], v[220:223], v[100:103], v[168:171]
  ds_read_b128 v[236:239], v252 offset:576
  v_mfma_f32_16x16x32_bf16 v[168:171], v[224:227], v[104:107], v[168:171]
  ds_read_b128 v[240:243], v252 offset:640
  v_mfma_f32_16x16x32_bf16 v[168:171], v[228:231], v[108:111], v[168:171]
  ds_read_b128 v[244:247], v252 offset:704
  v_mfma_f32_16x16x32_bf16 v[172:175], v[228:231], v[124:127], v[160:163]
  v_mfma_f32_16x16x32_bf16 v[172:175], v[224:227], v[120:123], v[172:175]
  v_mfma_f32_16x16x32_bf16 v[172:175], v[220:223], v[116:119], v[172:175]
  v_mfma_f32_16x16x32_bf16 v[172:175], v[216:219], v[112:115], v[172:175]
  v_mfma_f32_16x16x32_bf16 v[176:179], v[216:219], v[128:131], v[164:167]
  v_mfma_f32_16x16x32_bf16 v[176:179], v[220:223], v[132:135], v[176:179]
  v_mfma_f32_16x16x32_bf16 v[176:179], v[224:227], v[136:139], v[176:179]
  v_mfma_f32_16x16x32_bf16 v[176:179], v[228:231], v[140:143], v[176:179]
  v_exp_f32 v168, v168
  v_exp_f32 v169, v169
  v_exp_f32 v170, v170
  v_cvt_pk_bf16_f32 v192, v168, v169
  v_exp_f32 v171, v171
  v_dot2_f32_bf16 v150, v192, s48, 0
  v_cvt_pk_bf16_f32 v193, v170, v171
  v_dot2_f32_bf16 v150, v193, s48, v150
  s_waitcnt lgkmcnt(0)
  v_mfma_f32_16x16x32_bf16 v[180:183], v[232:235], v[96:99], v[156:159]
  ds_read_b128 v[216:219], v252 offset:16896
  v_mfma_f32_16x16x32_bf16 v[180:183], v[236:239], v[100:103], v[180:183]
  ds_read_b128 v[220:223], v252 offset:16960
  v_mfma_f32_16x16x32_bf16 v[180:183], v[240:243], v[104:107], v[180:183]
  ds_read_b128 v[224:227], v252 offset:17024
  v_mfma_f32_16x16x32_bf16 v[180:183], v[244:247], v[108:111], v[180:183]
  ds_read_b128 v[228:231], v252 offset:17088
  v_exp_f32 v172, v172
  v_exp_f32 v173, v173
  v_exp_f32 v174, v174
  v_cvt_pk_bf16_f32 v196, v172, v173
  v_exp_f32 v175, v175
  v_dot2_f32_bf16 v152, v196, s48, 0
  v_cvt_pk_bf16_f32 v197, v174, v175
  v_dot2_f32_bf16 v152, v197, s48, v152
  v_mfma_f32_16x16x32_bf16 v[184:187], v[244:247], v[124:127], v[160:163]
  v_mfma_f32_16x16x32_bf16 v[184:187], v[240:243], v[120:123], v[184:187]
  ds_read_addtid_b32 v255 offset:0
  v_mfma_f32_16x16x32_bf16 v[184:187], v[236:239], v[116:119], v[184:187]
  v_mfma_f32_16x16x32_bf16 v[184:187], v[232:235], v[112:115], v[184:187]
  v_exp_f32 v176, v176
  v_exp_f32 v177, v177
  v_exp_f32 v178, v178
  v_cvt_pk_bf16_f32 v200, v176, v177
  v_exp_f32 v179, v179
  v_dot2_f32_bf16 v154, v200, s48, 0
  v_cvt_pk_bf16_f32 v201, v178, v179
  v_dot2_f32_bf16 v154, v201, s48, v154
  v_mfma_f32_16x16x32_bf16 v[188:191], v[232:235], v[128:131], v[164:167]
  v_mfma_f32_16x16x32_bf16 v[188:191], v[236:239], v[132:135], v[188:191]
  v_mfma_f32_16x16x32_bf16 v[188:191], v[240:243], v[136:139], v[188:191]
  v_mfma_f32_16x16x32_bf16 v[188:191], v[244:247], v[140:143], v[188:191]
  v_exp_f32 v180, v180
  v_exp_f32 v181, v181
  v_exp_f32 v182, v182
  v_cvt_pk_bf16_f32 v194, v180, v181
  v_exp_f32 v183, v183
  v_dot2_f32_bf16 v150, v194, s48, v150
  v_cvt_pk_bf16_f32 v195, v182, v183
  v_dot2_f32_bf16 v150, v195, s48, v150
  s_waitcnt lgkmcnt(0)
  v_mfma_f32_16x16x32_bf16 v[168:171], v[216:219], v[96:99], v[156:159]
  ds_read_b128 v[232:235], v252 offset:17408
  v_mfma_f32_16x16x32_bf16 v[168:171], v[220:223], v[100:103], v[168:171]
  ds_read_b128 v[236:239], v252 offset:17472
  v_mfma_f32_16x16x32_bf16 v[168:171], v[224:227], v[104:107], v[168:171]
  ds_read_b128 v[240:243], v252 offset:17536
  v_mfma_f32_16x16x32_bf16 v[168:171], v[228:231], v[108:111], v[168:171]
  ds_read_b128 v[244:247], v252 offset:17600
  v_exp_f32 v184, v184
  v_exp_f32 v185, v185
  v_exp_f32 v186, v186
  v_cvt_pk_bf16_f32 v198, v184, v185
  v_exp_f32 v187, v187
  v_dot2_f32_bf16 v152, v198, s48, v152
  v_cvt_pk_bf16_f32 v199, v186, v187
  v_dot2_f32_bf16 v152, v199, s48, v152
  v_mfma_f32_16x16x32_bf16 v[172:175], v[228:231], v[124:127], v[160:163]
  v_mfma_f32_16x16x32_bf16 v[172:175], v[224:227], v[120:123], v[172:175]
  v_mfma_f32_16x16x32_bf16 v[172:175], v[220:223], v[116:119], v[172:175]
  v_mfma_f32_16x16x32_bf16 v[172:175], v[216:219], v[112:115], v[172:175]
  v_exp_f32 v188, v188
  v_exp_f32 v189, v189
  v_exp_f32 v190, v190
  v_cvt_pk_bf16_f32 v202, v188, v189
  v_exp_f32 v191, v191
  v_dot2_f32_bf16 v154, v202, s48, v154
  v_cvt_pk_bf16_f32 v203, v190, v191
  v_dot2_f32_bf16 v154, v203, s48, v154
  v_mfma_f32_16x16x32_bf16 v[176:179], v[216:219], v[128:131], v[164:167]
  v_mfma_f32_16x16x32_bf16 v[176:179], v[220:223], v[132:135], v[176:179]
  v_cmp_gt_u32 vcc, s44, v255
  v_mfma_f32_16x16x32_bf16 v[176:179], v[224:227], v[136:139], v[176:179]
  v_mfma_f32_16x16x32_bf16 v[176:179], v[228:231], v[140:143], v[176:179]
  s_cbranch_vccnz L_spin_v
L_spun_v:
  v_exp_f32 v168, v168
  v_exp_f32 v169, v169
  v_exp_f32 v170, v170
  v_cvt_pk_bf16_f32 v204, v168, v169
  v_exp_f32 v171, v171
  v_dot2_f32_bf16 v150, v204, s48, v150
  v_cvt_pk_bf16_f32 v205, v170, v171
  v_dot2_f32_bf16 v150, v205, s48, v150
  s_waitcnt lgkmcnt(0)
  v_mfma_f32_16x16x32_bf16 v[180:183], v[232:235], v[96:99], v[156:159]
  ds_read_b64_tr_b16 v[216:217], v253 offset:0
  ds_read_b64_tr_b16 v[218:219], v253 offset:512
  ds_read_b64_tr_b16 v[220:221], v253 offset:16896
  ds_read_b64_tr_b16 v[222:223], v253 offset:17408
  ds_read_b64_tr_b16 v[224:225], v253 offset:32
  ds_read_b64_tr_b16 v[226:227], v253 offset:544
  ds_read_b64_tr_b16 v[228:229], v253 offset:16928
  ds_read_b64_tr_b16 v[230:231], v253 offset:17440
  v_mfma_f32_16x16x32_bf16 v[180:183], v[236:239], v[100:103], v[180:183]
  v_mfma_f32_16x16x32_bf16 v[180:183], v[240:243], v[104:107], v[180:183]
  v_mfma_f32_16x16x32_bf16 v[180:183], v[244:247], v[108:111], v[180:183]
  v_exp_f32 v172, v172
  v_exp_f32 v173, v173
  v_exp_f32 v174, v174
  v_cvt_pk_bf16_f32 v208, v172, v173
  v_exp_f32 v175, v175
  v_dot2_f32_bf16 v152, v208, s48, v152
  v_cvt_pk_bf16_f32 v209, v174, v175
  v_dot2_f32_bf16 v152, v209, s48, v152
  v_mfma_f32_16x16x32_bf16 v[184:187], v[244:247], v[124:127], v[160:163]
  v_mfma_f32_16x16x32_bf16 v[184:187], v[240:243], v[120:123], v[184:187]
  v_mfma_f32_16x16x32_bf16 v[184:187], v[236:239], v[116:119], v[184:187]
  v_mfma_f32_16x16x32_bf16 v[184:187], v[232:235], v[112:115], v[184:187]
  v_exp_f32 v176, v176
  v_exp_f32 v177, v177
  v_exp_f32 v178, v178
  v_cvt_pk_bf16_f32 v212, v176, v177
  v_exp_f32 v179, v179
  v_dot2_f32_bf16 v154, v212, s48, v154
  v_cvt_pk_bf16_f32 v213, v178, v179
  v_dot2_f32_bf16 v154, v213, s48, v154
  v_mfma_f32_16x16x32_bf16 v[188:191], v[232:235], v[128:131], v[164:167]
  v_mfma_f32_16x16x32_bf16 v[188:191], v[236:239], v[132:135], v[188:191]
  v_mfma_f32_16x16x32_bf16 v[188:191], v[240:243], v[136:139], v[188:191]
  v_mfma_f32_16x16x32_bf16 v[188:191], v[244:247], v[140:143], v[188:191]
  v_exp_f32 v180, v180
  v_exp_f32 v181, v181
  v_exp_f32 v182, v182
  v_cvt_pk_bf16_f32 v206, v180, v181
  v_exp_f32 v183, v183
  v_dot2_f32_bf16 v150, v206, s48, v150
  v_cvt_pk_bf16_f32 v207, v182, v183
  v_dot2_f32_bf16 v150, v207, s48, v150
  v_exp_f32 v184, v184
  v_exp_f32 v185, v185
  v_exp_f32 v186, v186
  v_cvt_pk_bf16_f32 v210, v184, v185
  v_exp_f32 v187, v187
  v_dot2_f32_bf16 v152, v210, s48, v152
  v_cvt_pk_bf16_f32 v211, v186, v187
  v_dot2_f32_bf16 v152, v211, s48, v152
  v_exp_f32 v188, v188
  v_exp_f32 v189, v189
  v_exp_f32 v190, v190
  v_cvt_pk_bf16_f32 v214, v188, v189
  v_exp_f32 v191, v191
  v_dot2_f32_bf16 v154, v214, s48, v154
  v_cvt_pk_bf16_f32 v215, v190, v191
  v_dot2_f32_bf16 v154, v215, s48, v154
  s_nop 2
  v_max3_f32 v254, v150, v152, v154
  v_cmp_lt_f32 vcc, 2.0, v254
  s_nop 0
  s_cbranch_vccnz L_slow
  s_waitcnt lgkmcnt(4)
  v_mfma_f32_16x16x32_bf16 v[0:3], v[216:219], v[192:195], v[0:3]
  ds_read_b64_tr_b16 v[232:233], v253 offset:64
  ds_read_b64_tr_b16 v[234:235], v253 offset:576
  v_mfma_f32_16x16x32_bf16 v[0:3], v[220:223], v[204:207], v[0:3]
  ds_read_b64_tr_b16 v[236:237], v253 offset:16960
  v_mfma_f32_16x16x32_bf16 v[4:7], v[220:223], v[208:211], v[4:7]
  ds_read_b64_tr_b16 v[238:239], v253 offset:17472
  v_mfma_f32_16x16x32_bf16 v[4:7], v[216:219], v[196:199], v[4:7]
  ds_read_b64_tr_b16 v[240:241], v253 offset:96
  ds_read_b64_tr_b16 v[242:243], v253 offset:608
  v_mfma_f32_16x16x32_bf16 v[8:11], v[216:219], v[200:203], v[8:11]
  ds_read_b64_tr_b16 v[244:245], v253 offset:16992
  v_mfma_f32_16x16x32_bf16 v[8:11], v[220:223], v[212:215], v[8:11]
  ds_read_b64_tr_b16 v[246:247], v253 offset:17504
  s_waitcnt lgkmcnt(8)
  v_mfma_f32_16x16x32_bf16 v[20:23], v[228:231], v[212:215], v[20:23]
  v_mfma_f32_16x16x32_bf16 v[20:23], v[224:227], v[200:203], v[20:23]
  s_add_u32 s44, s44, 1
  v_mfma_f32_16x16x32_bf16 v[16:19], v[224:227], v[196:199], v[16:19]
  v_add_f32 v144, v144, v150
  v_mfma_f32_16x16x32_bf16 v[16:19], v[228:231], v[208:211], v[16:19]
  v_add_f32 v146, v146, v152
  v_mfma_f32_16x16x32_bf16 v[12:15], v[228:231], v[204:207], v[12:15]
  v_add_f32 v148, v148, v154
  v_mfma_f32_16x16x32_bf16 v[12:15], v[224:227], v[192:195], v[12:15]
  s_waitcnt lgkmcnt(4)
  v_mfma_f32_16x16x32_bf16 v[24:27], v[232:235], v[192:195], v[24:27]
  ds_read_b64_tr_b16 v[216:217], v253 offset:128
  ds_read_b64_tr_b16 v[218:219], v253 offset:640
  ds_read_b64_tr_b16 v[220:221], v253 offset:17024
  ds_read_b64_tr_b16 v[222:223], v253 offset:17536
  ds_read_b64_tr_b16 v[224:225], v253 offset:160
  ds_read_b64_tr_b16 v[226:227], v253 offset:672
  ds_read_b64_tr_b16 v[228:229], v253 offset:17056
  ds_read_b64_tr_b16 v[230:231], v253 offset:17568
  v_mfma_f32_16x16x32_bf16 v[24:27], v[236:239], v[204:207], v[24:27]
  v_mfma_f32_16x16x32_bf16 v[28:31], v[236:239], v[208:211], v[28:31]
  v_mfma_f32_16x16x32_bf16 v[28:31], v[232:235], v[196:199], v[28:31]
  v_mfma_f32_16x16x32_bf16 v[32:35], v[232:235], v[200:203], v[32:35]
  v_mfma_f32_16x16x32_bf16 v[32:35], v[236:239], v[212:215], v[32:35]
  s_waitcnt lgkmcnt(8)
  v_mfma_f32_16x16x32_bf16 v[44:47], v[244:247], v[212:215], v[44:47]
  v_mfma_f32_16x16x32_bf16 v[44:47], v[240:243], v[200:203], v[44:47]
  ds_read_addtid_b32 v255 offset:0
  v_mfma_f32_16x16x32_bf16 v[40:43], v[240:243], v[196:199], v[40:43]
  s_and_b32 s49, s44, 6
  v_mfma_f32_16x16x32_bf16 v[40:43], v[244:247], v[208:211], v[40:43]
  s_cselect_b32 s45, s46, s47
  v_mfma_f32_16x16x32_bf16 v[36:39], v[244:247], v[204:207], v[36:39]
  v_add_u32 v252, s45, v252
  v_mfma_f32_16x16x32_bf16 v[36:39], v[240:243], v[192:195], v[36:39]
  s_waitcnt lgkmcnt(0)
  v_mfma_f32_16x16x32_bf16 v[48:51], v[216:219], v[192:195], v[48:51]
  ds_read_b64_tr_b16 v[232:233], v253 offset:192
  ds_read_b64_tr_b16 v[234:235], v253 offset:704
  v_mfma_f32_16x16x32_bf16 v[48:51], v[220:223], v[204:207], v[48:51]
  ds_read_b64_tr_b16 v[236:237], v253 offset:17088
  v_mfma_f32_16x16x32_bf16 v[52:55], v[220:223], v[208:211], v[52:55]
  ds_read_b64_tr_b16 v[238:239], v253 offset:17600
  v_mfma_f32_16x16x32_bf16 v[52:55], v[216:219], v[196:199], v[52:55]
  ds_read_b64_tr_b16 v[240:241], v253 offset:224
  ds_read_b64_tr_b16 v[242:243], v253 offset:736
  v_mfma_f32_16x16x32_bf16 v[56:59], v[216:219], v[200:203], v[56:59]
  ds_read_b64_tr_b16 v[244:245], v253 offset:17120
  v_mfma_f32_16x16x32_bf16 v[56:59], v[220:223], v[212:215], v[56:59]
  ds_read_b64_tr_b16 v[246:247], v253 offset:17632
  v_mfma_f32_16x16x32_bf16 v[68:71], v[228:231], v[212:215], v[68:71]
  v_cmp_gt_u32 vcc, s44, v255
  v_mfma_f32_16x16x32_bf16 v[68:71], v[224:227], v[200:203], v[68:71]
  s_cbranch_vccnz L_spin_k
L_spun_k:
  v_mfma_f32_16x16x32_bf16 v[64:67], v[224:227], v[196:199], v[64:67]
  v_add_u32 v253, s45, v253
  s_sub_u32 s49, s25, s63
  v_mfma_f32_16x16x32_bf16 v[64:67], v[228:231], v[208:211], v[64:67]
  s_mov_b32 s25, s63
  s_min_u32 s49, s49, 15
  v_mfma_f32_16x16x32_bf16 v[60:63], v[228:231], v[204:207], v[60:63]
  s_lshl4_add_u32 s49, s44, s49
  v_mov_b32 v248, s49
  v_mfma_f32_16x16x32_bf16 v[60:63], v[224:227], v[192:195], v[60:63]
  ds_write_addtid_b32 v248 offset:256
  s_waitcnt lgkmcnt(5)
  v_mfma_f32_16x16x32_bf16 v[72:75], v[232:235], v[192:195], v[72:75]
  ds_read_b128 v[216:219], v252 offset:0
  v_mfma_f32_16x16x32_bf16 v[72:75], v[236:239], v[204:207], v[72:75]
  ds_read_b128 v[220:223], v252 offset:64
  v_mfma_f32_16x16x32_bf16 v[76:79], v[236:239], v[208:211], v[76:79]
  ds_read_b128 v[224:227], v252 offset:128
  v_mfma_f32_16x16x32_bf16 v[76:79], v[232:235], v[196:199], v[76:79]
  ds_read_b128 v[228:231], v252 offset:192
  v_mfma_f32_16x16x32_bf16 v[80:83], v[232:235], v[200:203], v[80:83]
  v_mfma_f32_16x16x32_bf16 v[80:83], v[236:239], v[212:215], v[80:83]
  s_add_u32 s44, s44, 1
  s_waitcnt lgkmcnt(5)
  v_mfma_f32_16x16x32_bf16 v[92:95], v[244:247], v[212:215], v[92:95]
  v_mfma_f32_16x16x32_bf16 v[92:95], v[240:243], v[200:203], v[92:95]
  s_cmp_lg_u32 s44, 194
  v_mfma_f32_16x16x32_bf16 v[88:91], v[240:243], v[196:199], v[88:91]
  v_mfma_f32_16x16x32_bf16 v[88:91], v[244:247], v[208:211], v[88:91]
  v_mfma_f32_16x16x32_bf16 v[84:87], v[244:247], v[204:207], v[84:87]
  v_mfma_f32_16x16x32_bf16 v[84:87], v[240:243], v[192:195], v[84:87]
  s_cbranch_scc1 L_body
L_final:
  v_mov_b32 v145, v144
  v_mov_b32 v147, v146
  v_mov_b32 v149, v148
  s_nop 0
  v_permlane32_swap_b32 v144, v145
  v_permlane32_swap_b32 v146, v147
  v_permlane32_swap_b32 v148, v149
  v_add_f32 v144, v144, v145
  v_add_f32 v146, v146, v147
  v_add_f32 v148, v148, v149
  v_mov_b32 v145, v144
  v_mov_b32 v147, v146
  v_mov_b32 v149, v148
  s_nop 0
  v_permlane16_swap_b32 v144, v145
  v_permlane16_swap_b32 v146, v147
  v_permlane16_swap_b32 v148, v149
  v_add_f32 v144, v144, v145
  v_add_f32 v146, v146, v147
  v_add_f32 v148, v148, v149
  s_waitcnt lgkmcnt(0)
  s_nop 3
  v_mov_b32 v255, 0x100000
  ds_write_addtid_b32 v255 offset:256
  v_mbcnt_lo_u32_b32 v254, -1, 0
  v_mbcnt_hi_u32_b32 v254, -1, v254
  v_lshlrev_b32 v252, 4, v254
  v_lshlrev_b32 v254, 2, v254
  v_rcp_f32 v156, v144
  v_rcp_f32 v160, v146
  v_rcp_f32 v164, v148
  s_nop 0
  v_pk_mul_f32 v[0:1], v[0:1], v[156:157] op_sel_hi:[1,0]
  v_pk_mul_f32 v[2:3], v[2:3], v[156:157] op_sel_hi:[1,0]
  v_pk_mul_f32 v[12:13], v[12:13], v[156:157] op_sel_hi:[1,0]
  v_pk_mul_f32 v[14:15], v[14:15], v[156:157] op_sel_hi:[1,0]
  v_cvt_pk_bf16_f32 v168, v0, v1
  v_cvt_pk_bf16_f32 v169, v2, v3
  v_cvt_pk_bf16_f32 v170, v12, v13
  v_cvt_pk_bf16_f32 v171, v14, v15
  buffer_store_dwordx4 v[168:171], v252, s[36:39], s54 offen offset:0 sc1
  v_pk_mul_f32 v[4:5], v[4:5], v[160:161] op_sel_hi:[1,0]
  v_pk_mul_f32 v[6:7], v[6:7], v[160:161] op_sel_hi:[1,0]
  v_pk_mul_f32 v[16:17], v[16:17], v[160:161] op_sel_hi:[1,0]
  v_pk_mul_f32 v[18:19], v[18:19], v[160:161] op_sel_hi:[1,0]
  v_cvt_pk_bf16_f32 v172, v4, v5
  v_cvt_pk_bf16_f32 v173, v6, v7
  v_cvt_pk_bf16_f32 v174, v16, v17
  v_cvt_pk_bf16_f32 v175, v18, v19
  buffer_store_dwordx4 v[172:175], v252, s[36:39], s54 offen offset:1024 sc1
  v_pk_mul_f32 v[8:9], v[8:9], v[164:165] op_sel_hi:[1,0]
  v_pk_mul_f32 v[10:11], v[10:11], v[164:165] op_sel_hi:[1,0]
  v_pk_mul_f32 v[20:21], v[20:21], v[164:165] op_sel_hi:[1,0]
  v_pk_mul_f32 v[22:23], v[22:23], v[164:165] op_sel_hi:[1,0]
  v_cvt_pk_bf16_f32 v176, v8, v9
  v_cvt_pk_bf16_f32 v177, v10, v11
  v_cvt_pk_bf16_f32 v178, v20, v21
  v_cvt_pk_bf16_f32 v179, v22, v23
  buffer_store_dwordx4 v[176:179], v252, s[36:39], s54 offen offset:2048 sc1
  s_add_u32 s54, s54, 12288
  v_pk_mul_f32 v[24:25], v[24:25], v[156:157] op_sel_hi:[1,0]
  v_pk_mul_f32 v[26:27], v[26:27], v[156:157] op_sel_hi:[1,0]
  v_pk_mul_f32 v[36:37], v[36:37], v[156:157] op_sel_hi:[1,0]
  v_pk_mul_f32 v[38:39], v[38:39], v[156:157] op_sel_hi:[1,0]
  v_cvt_pk_bf16_f32 v180, v24, v25
  v_cvt_pk_bf16_f32 v181, v26, v27
  v_cvt_pk_bf16_f32 v182, v36, v37
  v_cvt_pk_bf16_f32 v183, v38, v39
  buffer_store_dwordx4 v[180:183], v252, s[36:39], s54 offen offset:0 sc1
  v_pk_mul_f32 v[28:29], v[28:29], v[160:161] op_sel_hi:[1,0]
  v_pk_mul_f32 v[30:31], v[30:31], v[160:161] op_sel_hi:[1,0]
  v_pk_mul_f32 v[40:41], v[40:41], v[160:161] op_sel_hi:[1,0]
  v_pk_mul_f32 v[42:43], v[42:43], v[160:161] op_sel_hi:[1,0]
  v_cvt_pk_bf16_f32 v184, v28, v29
  v_cvt_pk_bf16_f32 v185, v30, v31
  v_cvt_pk_bf16_f32 v186, v40, v41
  v_cvt_pk_bf16_f32 v187, v42, v43
  buffer_store_dwordx4 v[184:187], v252, s[36:39], s54 offen offset:1024 sc1
  v_pk_mul_f32 v[32:33], v[32:33], v[164:165] op_sel_hi:[1,0]
  v_pk_mul_f32 v[34:35], v[34:35], v[164:165] op_sel_hi:[1,0]
  v_pk_mul_f32 v[44:45], v[44:45], v[164:165] op_sel_hi:[1,0]
  v_pk_mul_f32 v[46:47], v[46:47], v[164:165] op_sel_hi:[1,0]
  v_cvt_pk_bf16_f32 v188, v32, v33
  v_cvt_pk_bf16_f32 v189, v34, v35
  v_cvt_pk_bf16_f32 v190, v44, v45
  v_cvt_pk_bf16_f32 v191, v46, v47
  buffer_store_dwordx4 v[188:191], v252, s[36:39], s54 offen offset:2048 sc1
  s_add_u32 s54, s54, 12288
  v_pk_mul_f32 v[48:49], v[48:49], v[156:157] op_sel_hi:[1,0]
  v_pk_mul_f32 v[50:51], v[50:51], v[156:157] op_sel_hi:[1,0]
  v_pk_mul_f32 v[60:61], v[60:61], v[156:157] op_sel_hi:[1,0]
  v_pk_mul_f32 v[62:63], v[62:63], v[156:157] op_sel_hi:[1,0]
  v_cvt_pk_bf16_f32 v192, v48, v49
  v_cvt_pk_bf16_f32 v193, v50, v51
  v_cvt_pk_bf16_f32 v194, v60, v61
  v_cvt_pk_bf16_f32 v195, v62, v63
  buffer_store_dwordx4 v[192:195], v252, s[36:39], s54 offen offset:0 sc1
  v_pk_mul_f32 v[52:53], v[52:53], v[160:161] op_sel_hi:[1,0]
  v_pk_mul_f32 v[54:55], v[54:55], v[160:161] op_sel_hi:[1,0]
  v_pk_mul_f32 v[64:65], v[64:65], v[160:161] op_sel_hi:[1,0]
  v_pk_mul_f32 v[66:67], v[66:67], v[160:161] op_sel_hi:[1,0]
  v_cvt_pk_bf16_f32 v196, v52, v53
  v_cvt_pk_bf16_f32 v197, v54, v55
  v_cvt_pk_bf16_f32 v198, v64, v65
  v_cvt_pk_bf16_f32 v199, v66, v67
  buffer_store_dwordx4 v[196:199], v252, s[36:39], s54 offen offset:1024 sc1
  v_pk_mul_f32 v[56:57], v[56:57], v[164:165] op_sel_hi:[1,0]
  v_pk_mul_f32 v[58:59], v[58:59], v[164:165] op_sel_hi:[1,0]
  v_pk_mul_f32 v[68:69], v[68:69], v[164:165] op_sel_hi:[1,0]
  v_pk_mul_f32 v[70:71], v[70:71], v[164:165] op_sel_hi:[1,0]
  v_cvt_pk_bf16_f32 v200, v56, v57
  v_cvt_pk_bf16_f32 v201, v58, v59
  v_cvt_pk_bf16_f32 v202, v68, v69
  v_cvt_pk_bf16_f32 v203, v70, v71
  buffer_store_dwordx4 v[200:203], v252, s[36:39], s54 offen offset:2048 sc1
  s_add_u32 s54, s54, 12288
  v_pk_mul_f32 v[72:73], v[72:73], v[156:157] op_sel_hi:[1,0]
  v_pk_mul_f32 v[74:75], v[74:75], v[156:157] op_sel_hi:[1,0]
  v_pk_mul_f32 v[84:85], v[84:85], v[156:157] op_sel_hi:[1,0]
  v_pk_mul_f32 v[86:87], v[86:87], v[156:157] op_sel_hi:[1,0]
  v_cvt_pk_bf16_f32 v204, v72, v73
  v_cvt_pk_bf16_f32 v205, v74, v75
  v_cvt_pk_bf16_f32 v206, v84, v85
  v_cvt_pk_bf16_f32 v207, v86, v87
  buffer_store_dwordx4 v[204:207], v252, s[36:39], s54 offen offset:0 sc1
  v_pk_mul_f32 v[76:77], v[76:77], v[160:161] op_sel_hi:[1,0]
  v_pk_mul_f32 v[78:79], v[78:79], v[160:161] op_sel_hi:[1,0]
  v_pk_mul_f32 v[88:89], v[88:89], v[160:161] op_sel_hi:[1,0]
  v_pk_mul_f32 v[90:91], v[90:91], v[160:161] op_sel_hi:[1,0]
  v_cvt_pk_bf16_f32 v208, v76, v77
  v_cvt_pk_bf16_f32 v209, v78, v79
  v_cvt_pk_bf16_f32 v210, v88, v89
  v_cvt_pk_bf16_f32 v211, v90, v91
  buffer_store_dwordx4 v[208:211], v252, s[36:39], s54 offen offset:1024 sc1
  v_pk_mul_f32 v[80:81], v[80:81], v[164:165] op_sel_hi:[1,0]
  v_pk_mul_f32 v[82:83], v[82:83], v[164:165] op_sel_hi:[1,0]
  v_pk_mul_f32 v[92:93], v[92:93], v[164:165] op_sel_hi:[1,0]
  v_pk_mul_f32 v[94:95], v[94:95], v[164:165] op_sel_hi:[1,0]
  v_cvt_pk_bf16_f32 v212, v80, v81
  v_cvt_pk_bf16_f32 v213, v82, v83
  v_cvt_pk_bf16_f32 v214, v92, v93
  v_cvt_pk_bf16_f32 v215, v94, v95
  buffer_store_dwordx4 v[212:215], v252, s[36:39], s54 offen offset:2048 sc1
  s_add_u32 s54, s54, 12288
  v_mov_b32 v0, 0
  s_add_u32 s86, s86, 1
  v_mov_b32 v1, s86
L_tail:
  s_setprio 0
  s_cmp_ge_u32 s2, 240
  s_cbranch_scc1 L_notile
  v_lshrrev_b32 v248, 5, v254
  v_mul_u32_u24 v248, 5120, v248
  v_and_b32 v249, 0x70, v252
  v_add_u32 v253, v248, v249
  v_bfe_u32 v248, v254, 4, 2
  v_mul_u32_u24 v248, 1056, v248
  v_lshrrev_b32 v249, 6, v254
  v_lshl_add_u32 v248, v249, 7, v248
  v_and_b32 v249, 12, v254
  v_lshlrev_b32 v245, 7, v249
  v_lshl_add_u32 v248, v249, 1, v248
  v_add_u32 v250, s84, v248
  s_lshl_b32 s49, s62, 6
  v_mov_b32 v244, s49
  s_mov_b32 s96, 0
  ds_read_b32 v249, v244
  s_waitcnt lgkmcnt(0)
  v_cmp_gt_u32 vcc, 0x8001, v249
  s_nop 1
  s_cbranch_vccnz L_st_no
L_st:
  s_sub_u32 s63, s63, 1
  s_cbranch_scc1 L_end
  ds_read_b32 v249, v244 offset:0
  s_waitcnt lgkmcnt(0)
  v_cmp_gt_u32 vcc, 0x8001, v249
  s_nop 1
  s_cbranch_vccz L_st_d
  s_sleep 1
  s_branch L_st
L_st_d:
  s_cmp_eq_u32 s62, 0
  s_cbranch_scc1 L_fill0
  ds_read_b64_tr_b16 v[64:65], v250 offset:0
  ds_read_b64_tr_b16 v[66:67], v250 offset:512
  ds_read_b64_tr_b16 v[68:69], v250 offset:32
  ds_read_b64_tr_b16 v[70:71], v250 offset:544
  ds_read_b64_tr_b16 v[72:73], v250 offset:64
  ds_read_b64_tr_b16 v[74:75], v250 offset:576
  ds_read_b64_tr_b16 v[76:77], v250 offset:96
  ds_read_b64_tr_b16 v[78:79], v250 offset:608
  ds_read_b64_tr_b16 v[80:81], v250 offset:4224
  ds_read_b64_tr_b16 v[82:83], v250 offset:4736
  ds_read_b64_tr_b16 v[84:85], v250 offset:4256
  ds_read_b64_tr_b16 v[86:87], v250 offset:4768
  ds_read_b64_tr_b16 v[88:89], v250 offset:4288
  ds_read_b64_tr_b16 v[90:91], v250 offset:4800
  ds_read_b64_tr_b16 v[92:93], v250 offset:4320
  ds_read_b64_tr_b16 v[94:95], v250 offset:4832
  s_waitcnt lgkmcnt(8)
  s_add_u32 s49, s90, 0
  s_add_u32 m0, s84, 0
  s_nop 0
  buffer_load_dwordx4 v253, s[40:43], s49 offen offset:0 lds
  s_add_u32 m0, s84, -224
  s_nop 0
  buffer_load_dwordx4 v253, s[40:43], s49 offen offset:1280 lds
  s_add_u32 m0, s84, -448
  s_nop 0
  buffer_load_dwordx4 v253, s[40:43], s49 offen offset:2560 lds
  s_add_u32 m0, s84, -672
  s_nop 0
  buffer_load_dwordx4 v253, s[40:43], s49 offen offset:3840 lds
  ds_read_b64_tr_b16 v[96:97], v250 offset:8448
  ds_read_b64_tr_b16 v[98:99], v250 offset:8960
  ds_read_b64_tr_b16 v[100:101], v250 offset:8480
  ds_read_b64_tr_b16 v[102:103], v250 offset:8992
  ds_read_b64_tr_b16 v[104:105], v250 offset:8512
  ds_read_b64_tr_b16 v[106:107], v250 offset:9024
  ds_read_b64_tr_b16 v[108:109], v250 offset:8544
  ds_read_b64_tr_b16 v[110:111], v250 offset:9056
  s_waitcnt lgkmcnt(8)
  s_add_u32 s49, s90, 40960
  s_add_u32 m0, s84, 4224
  s_nop 0
  buffer_load_dwordx4 v253, s[40:43], s49 offen offset:0 lds
  s_add_u32 m0, s84, 4000
  s_nop 0
  buffer_load_dwordx4 v253, s[40:43], s49 offen offset:1280 lds
  s_add_u32 m0, s84, 3776
  s_nop 0
  buffer_load_dwordx4 v253, s[40:43], s49 offen offset:2560 lds
  s_add_u32 m0, s84, 3552
  s_nop 0
  buffer_load_dwordx4 v253, s[40:43], s49 offen offset:3840 lds
  s_cmp_eq_u32 s96, 0
  s_cbranch_scc1 L_fst
L_fsd:
  ds_read_b64_tr_b16 v[112:113], v250 offset:12672
  ds_read_b64_tr_b16 v[114:115], v250 offset:13184
  ds_read_b64_tr_b16 v[116:117], v250 offset:12704
  ds_read_b64_tr_b16 v[118:119], v250 offset:13216
  ds_read_b64_tr_b16 v[120:121], v250 offset:12736
  ds_read_b64_tr_b16 v[122:123], v250 offset:13248
  ds_read_b64_tr_b16 v[124:125], v250 offset:12768
  ds_read_b64_tr_b16 v[126:127], v250 offset:13280
  s_waitcnt lgkmcnt(8)
  s_add_u32 s49, s90, 81920
  s_add_u32 m0, s84, 8448
  s_nop 0
  buffer_load_dwordx4 v253, s[40:43], s49 offen offset:0 lds
  s_add_u32 m0, s84, 8224
  s_nop 0
  buffer_load_dwordx4 v253, s[40:43], s49 offen offset:1280 lds
  s_add_u32 m0, s84, 8000
  s_nop 0
  buffer_load_dwordx4 v253, s[40:43], s49 offen offset:2560 lds
  s_add_u32 m0, s84, 7776
  s_nop 0
  buffer_load_dwordx4 v253, s[40:43], s49 offen offset:3840 lds
  ds_read_b64_tr_b16 v[128:129], v250 offset:16896
  ds_read_b64_tr_b16 v[130:131], v250 offset:17408
  ds_read_b64_tr_b16 v[132:133], v250 offset:16928
  ds_read_b64_tr_b16 v[134:135], v250 offset:17440
  ds_read_b64_tr_b16 v[136:137], v250 offset:16960
  ds_read_b64_tr_b16 v[138:139], v250 offset:17472
  ds_read_b64_tr_b16 v[140:141], v250 offset:16992
  ds_read_b64_tr_b16 v[142:143], v250 offset:17504
  s_waitcnt lgkmcnt(8)
  s_add_u32 s49, s90, 122880
  s_add_u32 m0, s84, 12672
  s_nop 0
  buffer_load_dwordx4 v253, s[40:43], s49 offen offset:0 lds
  s_add_u32 m0, s84, 12448
  s_nop 0
  buffer_load_dwordx4 v253, s[40:43], s49 offen offset:1280 lds
  s_add_u32 m0, s84, 12224
  s_nop 0
  buffer_load_dwordx4 v253, s[40:43], s49 offen offset:2560 lds
  s_add_u32 m0, s84, 12000
  s_nop 0
  buffer_load_dwordx4 v253, s[40:43], s49 offen offset:3840 lds
  ds_read_b64_tr_b16 v[144:145], v250 offset:21120
  ds_read_b64_tr_b16 v[146:147], v250 offset:21632
  ds_read_b64_tr_b16 v[148:149], v250 offset:21152
  ds_read_b64_tr_b16 v[150:151], v250 offset:21664
  ds_read_b64_tr_b16 v[152:153], v250 offset:21184
  ds_read_b64_tr_b16 v[154:155], v250 offset:21696
  ds_read_b64_tr_b16 v[156:157], v250 offset:21216
  ds_read_b64_tr_b16 v[158:159], v250 offset:21728
  s_waitcnt lgkmcnt(8)
  s_add_u32 s49, s91, 0
  s_add_u32 m0, s84, 16896
  s_nop 0
  buffer_load_dwordx4 v253, s[40:43], s49 offen offset:0 lds
  s_add_u32 m0, s84, 16672
  s_nop 0
  buffer_load_dwordx4 v253, s[40:43], s49 offen offset:1280 lds
  s_add_u32 m0, s84, 16448
  s_nop 0
  buffer_load_dwordx4 v253, s[40:43], s49 offen offset:2560 lds
  s_add_u32 m0, s84, 16224
  s_nop 0
  buffer_load_dwordx4 v253, s[40:43], s49 offen offset:3840 lds
  s_waitcnt vmcnt(20)
  ds_read_b64_tr_b16 v[160:161], v250 offset:25344
  ds_read_b64_tr_b16 v[162:163], v250 offset:25856
  ds_read_b64_tr_b16 v[164:165], v250 offset:25376
  ds_read_b64_tr_b16 v[166:167], v250 offset:25888
  ds_read_b64_tr_b16 v[168:169], v250 offset:25408
  ds_read_b64_tr_b16 v[170:171], v250 offset:25920
  ds_read_b64_tr_b16 v[172:173], v250 offset:25440
  ds_read_b64_tr_b16 v[174:175], v250 offset:25952
  s_waitcnt lgkmcnt(8)
  s_add_u32 s49, s91, 40960
  s_add_u32 m0, s84, 21120
  s_nop 0
  buffer_load_dwordx4 v253, s[40:43], s49 offen offset:0 lds
  s_add_u32 m0, s84, 20896
  s_nop 0
  buffer_load_dwordx4 v253, s[40:43], s49 offen offset:1280 lds
  s_add_u32 m0, s84, 20672
  s_nop 0
  buffer_load_dwordx4 v253, s[40:43], s49 offen offset:2560 lds
  s_add_u32 m0, s84, 20448
  s_nop 0
  buffer_load_dwordx4 v253, s[40:43], s49 offen offset:3840 lds
  ds_read_b64_tr_b16 v[176:177], v250 offset:29568
  ds_read_b64_tr_b16 v[178:179], v250 offset:30080
  ds_read_b64_tr_b16 v[180:181], v250 offset:29600
  ds_read_b64_tr_b16 v[182:183], v250 offset:30112
  ds_read_b64_tr_b16 v[184:185], v250 offset:29632
  ds_read_b64_tr_b16 v[186:187], v250 offset:30144
  ds_read_b64_tr_b16 v[188:189], v250 offset:29664
  ds_read_b64_tr_b16 v[190:191], v250 offset:30176
  s_waitcnt lgkmcnt(8)
  s_add_u32 s49, s91, 81920
  s_add_u32 m0, s84, 25344
  s_nop 0
  buffer_load_dwordx4 v253, s[40:43], s49 offen offset:0 lds
  s_add_u32 m0, s84, 25120
  s_nop 0
  buffer_load_dwordx4 v253, s[40:43], s49 offen offset:1280 lds
  s_add_u32 m0, s84, 24896
  s_nop 0
  buffer_load_dwordx4 v253, s[40:43], s49 offen offset:2560 lds
  s_add_u32 m0, s84, 24672
  s_nop 0
  buffer_load_dwordx4 v253, s[40:43], s49 offen offset:3840 lds
  s_waitcnt lgkmcnt(0)
  s_add_u32 s49, s91, 122880
  s_add_u32 m0, s84, 29568
  s_nop 0
  buffer_load_dwordx4 v253, s[40:43], s49 offen offset:0 lds
  s_add_u32 m0, s84, 29344
  s_nop 0
  buffer_load_dwordx4 v253, s[40:43], s49 offen offset:1280 lds
  s_add_u32 m0, s84, 29120
  s_nop 0
  buffer_load_dwordx4 v253, s[40:43], s49 offen offset:2560 lds
  s_add_u32 m0, s84, 28896
  s_nop 0
  buffer_load_dwordx4 v253, s[40:43], s49 offen offset:3840 lds
  s_waitcnt vmcnt(0)
L_tail3:
  s_barrier
  s_mov_b32 s96, 0
  s_add_u32 s51, s100, 0
  s_and_b32 s51, s51, 3
  s_add_u32 s51, s51, s99
L_rchk0:
  s_bitcmp1_b32 s96, s51
  s_cbranch_scc0 L_rpoll0
  s_add_u32 s50, s92, 0
  buffer_load_dwordx4 v[192:195], v252, s[36:39], s50 offen offset:0 sc1
  buffer_load_dwordx4 v[196:199], v252, s[36:39], s50 offen offset:1024 sc1
  buffer_load_dwordx4 v[200:203], v252, s[36:39], s50 offen offset:2048 sc1
  buffer_load_dwordx4 v[204:207], v252, s[36:39], s50 offen offset:3072 sc1
  s_add_u32 s50, s92, 12288
  buffer_load_dwordx4 v[208:211], v252, s[36:39], s50 offen offset:0 sc1
  buffer_load_dwordx4 v[212:215], v252, s[36:39], s50 offen offset:1024 sc1
  buffer_load_dwordx4 v[216:219], v252, s[36:39], s50 offen offset:2048 sc1
  buffer_load_dwordx4 v[220:223], v252, s[36:39], s50 offen offset:3072 sc1
  s_add_u32 s50, s92, 24576
  buffer_load_dwordx4 v[224:227], v252, s[36:39], s50 offen offset:0 sc1
  buffer_load_dwordx4 v[228:231], v252, s[36:39], s50 offen offset:1024 sc1
  buffer_load_dwordx4 v[232:235], v252, s[36:39], s50 offen offset:2048 sc1
  buffer_load_dwordx4 v[236:239], v252, s[36:39], s50 offen offset:3072 sc1
  s_waitcnt vmcnt(8)
  v_mfma_f32_16x16x32_bf16 v[0:3], v[64:67], v[192:195], 0
  v_mfma_f32_16x16x32_bf16 v[4:7], v[64:67], v[196:199], 0
  v_mfma_f32_16x16x32_bf16 v[8:11], v[64:67], v[200:203], 0
  v_mfma_f32_16x16x32_bf16 v[12:15], v[64:67], v[204:207], 0
  v_mfma_f32_16x16x32_bf16 v[28:31], v[68:71], v[204:207], 0
  v_mfma_f32_16x16x32_bf16 v[24:27], v[68:71], v[200:203], 0
  v_mfma_f32_16x16x32_bf16 v[20:23], v[68:71], v[196:199], 0
  v_mfma_f32_16x16x32_bf16 v[16:19], v[68:71], v[192:195], 0
  v_mfma_f32_16x16x32_bf16 v[32:35], v[72:75], v[192:195], 0
  v_mfma_f32_16x16x32_bf16 v[36:39], v[72:75], v[196:199], 0
  v_mfma_f32_16x16x32_bf16 v[40:43], v[72:75], v[200:203], 0
  v_mfma_f32_16x16x32_bf16 v[44:47], v[72:75], v[204:207], 0
  v_mfma_f32_16x16x32_bf16 v[60:63], v[76:79], v[204:207], 0
  v_mfma_f32_16x16x32_bf16 v[56:59], v[76:79], v[200:203], 0
  v_mfma_f32_16x16x32_bf16 v[52:55], v[76:79], v[196:199], 0
  v_mfma_f32_16x16x32_bf16 v[48:51], v[76:79], v[192:195], 0
  s_add_u32 s50, s92, 36864
  buffer_load_dwordx4 v[192:195], v252, s[36:39], s50 offen offset:0 sc1
  buffer_load_dwordx4 v[196:199], v252, s[36:39], s50 offen offset:1024 sc1
  buffer_load_dwordx4 v[200:203], v252, s[36:39], s50 offen offset:2048 sc1
  buffer_load_dwordx4 v[204:207], v252, s[36:39], s50 offen offset:3072 sc1
  ds_read_b64_tr_b16 v[64:65], v250 offset:0
  ds_read_b64_tr_b16 v[66:67], v250 offset:512
  ds_read_b64_tr_b16 v[68:69], v250 offset:32
  ds_read_b64_tr_b16 v[70:71], v250 offset:544
  ds_read_b64_tr_b16 v[72:73], v250 offset:64
  ds_read_b64_tr_b16 v[74:75], v250 offset:576
  ds_read_b64_tr_b16 v[76:77], v250 offset:96
  ds_read_b64_tr_b16 v[78:79], v250 offset:608
  s_waitcnt vmcnt(8)
  v_mfma_f32_16x16x32_bf16 v[0:3], v[80:83], v[208:211], v[0:3]
  v_mfma_f32_16x16x32_bf16 v[4:7], v[80:83], v[212:215], v[4:7]
  v_mfma_f32_16x16x32_bf16 v[8:11], v[80:83], v[216:219], v[8:11]
  v_mfma_f32_16x16x32_bf16 v[12:15], v[80:83], v[220:223], v[12:15]
  v_mfma_f32_16x16x32_bf16 v[28:31], v[84:87], v[220:223], v[28:31]
  v_mfma_f32_16x16x32_bf16 v[24:27], v[84:87], v[216:219], v[24:27]
  v_mfma_f32_16x16x32_bf16 v[20:23], v[84:87], v[212:215], v[20:23]
  v_mfma_f32_16x16x32_bf16 v[16:19], v[84:87], v[208:211], v[16:19]
  v_mfma_f32_16x16x32_bf16 v[32:35], v[88:91], v[208:211], v[32:35]
  v_mfma_f32_16x16x32_bf16 v[36:39], v[88:91], v[212:215], v[36:39]
  v_mfma_f32_16x16x32_bf16 v[40:43], v[88:91], v[216:219], v[40:43]
  v_mfma_f32_16x16x32_bf16 v[44:47], v[88:91], v[220:223], v[44:47]
  v_mfma_f32_16x16x32_bf16 v[60:63], v[92:95], v[220:223], v[60:63]
  v_mfma_f32_16x16x32_bf16 v[56:59], v[92:95], v[216:219], v[56:59]
  v_mfma_f32_16x16x32_bf16 v[52:55], v[92:95], v[212:215], v[52:55]
  v_mfma_f32_16x16x32_bf16 v[48:51], v[92:95], v[208:211], v[48:51]
  s_add_u32 s51, s100, 1
  s_and_b32 s51, s51, 3
  s_add_u32 s51, s51, s99
L_rchk1:
  s_bitcmp1_b32 s96, s51
  s_cbranch_scc0 L_rpoll1
  s_add_u32 s50, s93, 0
  buffer_load_dwordx4 v[208:211], v252, s[36:39], s50 offen offset:0 sc1
  buffer_load_dwordx4 v[212:215], v252, s[36:39], s50 offen offset:1024 sc1
  buffer_load_dwordx4 v[216:219], v252, s[36:39], s50 offen offset:2048 sc1
  buffer_load_dwordx4 v[220:223], v252, s[36:39], s50 offen offset:3072 sc1
  ds_read_b64_tr_b16 v[80:81], v250 offset:4224
  ds_read_b64_tr_b16 v[82:83], v250 offset:4736
  ds_read_b64_tr_b16 v[84:85], v250 offset:4256
  ds_read_b64_tr_b16 v[86:87], v250 offset:4768
  ds_read_b64_tr_b16 v[88:89], v250 offset:4288
  ds_read_b64_tr_b16 v[90:91], v250 offset:4800
  ds_read_b64_tr_b16 v[92:93], v250 offset:4320
  ds_read_b64_tr_b16 v[94:95], v250 offset:4832
  s_waitcnt vmcnt(8)
  v_mfma_f32_16x16x32_bf16 v[0:3], v[96:99], v[224:227], v[0:3]
  v_mfma_f32_16x16x32_bf16 v[4:7], v[96:99], v[228:231], v[4:7]
  v_mfma_f32_16x16x32_bf16 v[8:11], v[96:99], v[232:235], v[8:11]
  v_mfma_f32_16x16x32_bf16 v[12:15], v[96:99], v[236:239], v[12:15]
  v_mfma_f32_16x16x32_bf16 v[28:31], v[100:103], v[236:239], v[28:31]
  v_mfma_f32_16x16x32_bf16 v[24:27], v[100:103], v[232:235], v[24:27]
  v_mfma_f32_16x16x32_bf16 v[20:23], v[100:103], v[228:231], v[20:23]
  v_mfma_f32_16x16x32_bf16 v[16:19], v[100:103], v[224:227], v[16:19]
  v_mfma_f32_16x16x32_bf16 v[32:35], v[104:107], v[224:227], v[32:35]
  v_mfma_f32_16x16x32_bf16 v[36:39], v[104:107], v[228:231], v[36:39]
  v_mfma_f32_16x16x32_bf16 v[40:43], v[104:107], v[232:235], v[40:43]
  v_mfma_f32_16x16x32_bf16 v[44:47], v[104:107], v[236:239], v[44:47]
  v_mfma_f32_16x16x32_bf16 v[60:63], v[108:111], v[236:239], v[60:63]
  v_mfma_f32_16x16x32_bf16 v[56:59], v[108:111], v[232:235], v[56:59]
  v_mfma_f32_16x16x32_bf16 v[52:55], v[108:111], v[228:231], v[52:55]
  v_mfma_f32_16x16x32_bf16 v[48:51], v[108:111], v[224:227], v[48:51]
  s_add_u32 s50, s93, 12288
  buffer_load_dwordx4 v[224:227], v252, s[36:39], s50 offen offset:0 sc1
  buffer_load_dwordx4 v[228:231], v252, s[36:39], s50 offen offset:1024 sc1
  buffer_load_dwordx4 v[232:235], v252, s[36:39], s50 offen offset:2048 sc1
  buffer_load_dwordx4 v[236:239], v252, s[36:39], s50 offen offset:3072 sc1
  ds_read_b64_tr_b16 v[96:97], v250 offset:8448
  ds_read_b64_tr_b16 v[98:99], v250 offset:8960
  ds_read_b64_tr_b16 v[100:101], v250 offset:8480
  ds_read_b64_tr_b16 v[102:103], v250 offset:8992
  ds_read_b64_tr_b16 v[104:105], v250 offset:8512
  ds_read_b64_tr_b16 v[106:107], v250 offset:9024
  ds_read_b64_tr_b16 v[108:109], v250 offset:8544
  ds_read_b64_tr_b16 v[110:111], v250 offset:9056
  s_waitcnt vmcnt(8)
  v_mfma_f32_16x16x32_bf16 v[0:3], v[112:115], v[192:195], v[0:3]
  v_mfma_f32_16x16x32_bf16 v[4:7], v[112:115], v[196:199], v[4:7]
  v_mfma_f32_16x16x32_bf16 v[8:11], v[112:115], v[200:203], v[8:11]
  v_mfma_f32_16x16x32_bf16 v[12:15], v[112:115], v[204:207], v[12:15]
  v_mfma_f32_16x16x32_bf16 v[28:31], v[116:119], v[204:207], v[28:31]
  v_mfma_f32_16x16x32_bf16 v[24:27], v[116:119], v[200:203], v[24:27]
  v_mfma_f32_16x16x32_bf16 v[20:23], v[116:119], v[196:199], v[20:23]
  v_mfma_f32_16x16x32_bf16 v[16:19], v[116:119], v[192:195], v[16:19]
  v_mfma_f32_16x16x32_bf16 v[32:35], v[120:123], v[192:195], v[32:35]
  v_mfma_f32_16x16x32_bf16 v[36:39], v[120:123], v[196:199], v[36:39]
  v_mfma_f32_16x16x32_bf16 v[40:43], v[120:123], v[200:203], v[40:43]
  v_mfma_f32_16x16x32_bf16 v[44:47], v[120:123], v[204:207], v[44:47]
  v_mfma_f32_16x16x32_bf16 v[60:63], v[124:127], v[204:207], v[60:63]
  v_mfma_f32_16x16x32_bf16 v[56:59], v[124:127], v[200:203], v[56:59]
  v_mfma_f32_16x16x32_bf16 v[52:55], v[124:127], v[196:199], v[52:55]
  v_mfma_f32_16x16x32_bf16 v[48:51], v[124:127], v[192:195], v[48:51]
  s_add_u32 s50, s93, 24576
  buffer_load_dwordx4 v[192:195], v252, s[36:39], s50 offen offset:0 sc1
  buffer_load_dwordx4 v[196:199], v252, s[36:39], s50 offen offset:1024 sc1
  buffer_load_dwordx4 v[200:203], v252, s[36:39], s50 offen offset:2048 sc1
  buffer_load_dwordx4 v[204:207], v252, s[36:39], s50 offen offset:3072 sc1
  ds_read_b64_tr_b16 v[112:113], v250 offset:12672
  ds_read_b64_tr_b16 v[114:115], v250 offset:13184
  ds_read_b64_tr_b16 v[116:117], v250 offset:12704
  ds_read_b64_tr_b16 v[118:119], v250 offset:13216
  ds_read_b64_tr_b16 v[120:121], v250 offset:12736
  ds_read_b64_tr_b16 v[122:123], v250 offset:13248
  ds_read_b64_tr_b16 v[124:125], v250 offset:12768
  ds_read_b64_tr_b16 v[126:127], v250 offset:13280
  s_cmp_lt_u32 s62, 4
  s_cbranch_scc1 L_nomark
  s_and_b32 s49, s62, 3
  s_lshl_b32 s49, s49, 9
  v_add_u32 v247, s49, v254
  v_mov_b32 v246, 0x100001
  ds_write_b32 v247, v246 offset:0
L_nomark:
  s_waitcnt vmcnt(8)
  v_mfma_f32_16x16x32_bf16 v[0:3], v[128:131], v[208:211], v[0:3]
  v_mfma_f32_16x16x32_bf16 v[4:7], v[128:131], v[212:215], v[4:7]
  v_mfma_f32_16x16x32_bf16 v[8:11], v[128:131], v[216:219], v[8:11]
  v_mfma_f32_16x16x32_bf16 v[12:15], v[128:131], v[220:223], v[12:15]
  v_mfma_f32_16x16x32_bf16 v[28:31], v[132:135], v[220:223], v[28:31]
  v_mfma_f32_16x16x32_bf16 v[24:27], v[132:135], v[216:219], v[24:27]
  v_mfma_f32_16x16x32_bf16 v[20:23], v[132:135], v[212:215], v[20:23]
  v_mfma_f32_16x16x32_bf16 v[16:19], v[132:135], v[208:211], v[16:19]
  v_mfma_f32_16x16x32_bf16 v[32:35], v[136:139], v[208:211], v[32:35]
  v_mfma_f32_16x16x32_bf16 v[36:39], v[136:139], v[212:215], v[36:39]
  v_mfma_f32_16x16x32_bf16 v[40:43], v[136:139], v[216:219], v[40:43]
  v_mfma_f32_16x16x32_bf16 v[44:47], v[136:139], v[220:223], v[44:47]
  v_mfma_f32_16x16x32_bf16 v[60:63], v[140:143], v[220:223], v[60:63]
  v_mfma_f32_16x16x32_bf16 v[56:59], v[140:143], v[216:219], v[56:59]
  v_mfma_f32_16x16x32_bf16 v[52:55], v[140:143], v[212:215], v[52:55]
  v_mfma_f32_16x16x32_bf16 v[48:51], v[140:143], v[208:211], v[48:51]
  s_add_u32 s50, s93, 36864
  buffer_load_dwordx4 v[208:211], v252, s[36:39], s50 offen offset:0 sc1
  buffer_load_dwordx4 v[212:215], v252, s[36:39], s50 offen offset:1024 sc1
  buffer_load_dwordx4 v[216:219], v252, s[36:39], s50 offen offset:2048 sc1
  buffer_load_dwordx4 v[220:223], v252, s[36:39], s50 offen offset:3072 sc1
  ds_read_b64_tr_b16 v[128:129], v250 offset:16896
  ds_read_b64_tr_b16 v[130:131], v250 offset:17408
  ds_read_b64_tr_b16 v[132:133], v250 offset:16928
  ds_read_b64_tr_b16 v[134:135], v250 offset:17440
  ds_read_b64_tr_b16 v[136:137], v250 offset:16960
  ds_read_b64_tr_b16 v[138:139], v250 offset:17472
  ds_read_b64_tr_b16 v[140:141], v250 offset:16992
  ds_read_b64_tr_b16 v[142:143], v250 offset:17504
  s_waitcnt vmcnt(8)
  v_mfma_f32_16x16x32_bf16 v[0:3], v[144:147], v[224:227], v[0:3]
  v_mfma_f32_16x16x32_bf16 v[4:7], v[144:147], v[228:231], v[4:7]
  v_mfma_f32_16x16x32_bf16 v[8:11], v[144:147], v[232:235], v[8:11]
  v_mfma_f32_16x16x32_bf16 v[12:15], v[144:147], v[236:239], v[12:15]
  v_mfma_f32_16x16x32_bf16 v[28:31], v[148:151], v[236:239], v[28:31]
  v_mfma_f32_16x16x32_bf16 v[24:27], v[148:151], v[232:235], v[24:27]
  v_mfma_f32_16x16x32_bf16 v[20:23], v[148:151], v[228:231], v[20:23]
  v_mfma_f32_16x16x32_bf16 v[16:19], v[148:151], v[224:227], v[16:19]
  v_mfma_f32_16x16x32_bf16 v[32:35], v[152:155], v[224:227], v[32:35]
  v_mfma_f32_16x16x32_bf16 v[36:39], v[152:155], v[228:231], v[36:39]
  v_mfma_f32_16x16x32_bf16 v[40:43], v[152:155], v[232:235], v[40:43]
  v_mfma_f32_16x16x32_bf16 v[44:47], v[152:155], v[236:239], v[44:47]
  v_mfma_f32_16x16x32_bf16 v[60:63], v[156:159], v[236:239], v[60:63]
  v_mfma_f32_16x16x32_bf16 v[56:59], v[156:159], v[232:235], v[56:59]
  v_mfma_f32_16x16x32_bf16 v[52:55], v[156:159], v[228:231], v[52:55]
  v_mfma_f32_16x16x32_bf16 v[48:51], v[156:159], v[224:227], v[48:51]
  s_add_u32 s51, s100, 2
  s_and_b32 s51, s51, 3
  s_add_u32 s51, s51, s99
L_rchk2:
  s_bitcmp1_b32 s96, s51
  s_cbranch_scc0 L_rpoll2
  s_add_u32 s50, s94, 0
  buffer_load_dwordx4 v[224:227], v252, s[36:39], s50 offen offset:0 sc1
  buffer_load_dwordx4 v[228:231], v252, s[36:39], s50 offen offset:1024 sc1
  buffer_load_dwordx4 v[232:235], v252, s[36:39], s50 offen offset:2048 sc1
  buffer_load_dwordx4 v[236:239], v252, s[36:39], s50 offen offset:3072 sc1
  ds_read_b64_tr_b16 v[144:145], v250 offset:21120
  ds_read_b64_tr_b16 v[146:147], v250 offset:21632
  ds_read_b64_tr_b16 v[148:149], v250 offset:21152
  ds_read_b64_tr_b16 v[150:151], v250 offset:21664
  ds_read_b64_tr_b16 v[152:153], v250 offset:21184
  ds_read_b64_tr_b16 v[154:155], v250 offset:21696
  ds_read_b64_tr_b16 v[156:157], v250 offset:21216
  ds_read_b64_tr_b16 v[158:159], v250 offset:21728
  s_waitcnt vmcnt(8)
  v_mfma_f32_16x16x32_bf16 v[0:3], v[160:163], v[192:195], v[0:3]
  v_mfma_f32_16x16x32_bf16 v[4:7], v[160:163], v[196:199], v[4:7]
  v_mfma_f32_16x16x32_bf16 v[8:11], v[160:163], v[200:203], v[8:11]
  v_mfma_f32_16x16x32_bf16 v[12:15], v[160:163], v[204:207], v[12:15]
  v_mfma_f32_16x16x32_bf16 v[28:31], v[164:167], v[204:207], v[28:31]
  v_mfma_f32_16x16x32_bf16 v[24:27], v[164:167], v[200:203], v[24:27]
  v_mfma_f32_16x16x32_bf16 v[20:23], v[164:167], v[196:199], v[20:23]
  v_mfma_f32_16x16x32_bf16 v[16:19], v[164:167], v[192:195], v[16:19]
  v_mfma_f32_16x16x32_bf16 v[32:35], v[168:171], v[192:195], v[32:35]
  v_mfma_f32_16x16x32_bf16 v[36:39], v[168:171], v[196:199], v[36:39]
  v_mfma_f32_16x16x32_bf16 v[40:43], v[168:171], v[200:203], v[40:43]
  v_mfma_f32_16x16x32_bf16 v[44:47], v[168:171], v[204:207], v[44:47]
  v_mfma_f32_16x16x32_bf16 v[60:63], v[172:175], v[204:207], v[60:63]
  v_mfma_f32_16x16x32_bf16 v[56:59], v[172:175], v[200:203], v[56:59]
  v_mfma_f32_16x16x32_bf16 v[52:55], v[172:175], v[196:199], v[52:55]
  v_mfma_f32_16x16x32_bf16 v[48:51], v[172:175], v[192:195], v[48:51]
  s_add_u32 s50, s94, 12288
  buffer_load_dwordx4 v[192:195], v252, s[36:39], s50 offen offset:0 sc1
  buffer_load_dwordx4 v[196:199], v252, s[36:39], s50 offen offset:1024 sc1
  buffer_load_dwordx4 v[200:203], v252, s[36:39], s50 offen offset:2048 sc1
  buffer_load_dwordx4 v[204:207], v252, s[36:39], s50 offen offset:3072 sc1
  ds_read_b64_tr_b16 v[160:161], v250 offset:25344
  ds_read_b64_tr_b16 v[162:163], v250 offset:25856
  ds_read_b64_tr_b16 v[164:165], v250 offset:25376
  ds_read_b64_tr_b16 v[166:167], v250 offset:25888
  ds_read_b64_tr_b16 v[168:169], v250 offset:25408
  ds_read_b64_tr_b16 v[170:171], v250 offset:25920
  ds_read_b64_tr_b16 v[172:173], v250 offset:25440
  ds_read_b64_tr_b16 v[174:175], v250 offset:25952
  s_waitcnt vmcnt(8)
  v_mfma_f32_16x16x32_bf16 v[0:3], v[176:179], v[208:211], v[0:3]
  v_mfma_f32_16x16x32_bf16 v[4:7], v[176:179], v[212:215], v[4:7]
  v_mfma_f32_16x16x32_bf16 v[8:11], v[176:179], v[216:219], v[8:11]
  v_mfma_f32_16x16x32_bf16 v[12:15], v[176:179], v[220:223], v[12:15]
  v_mfma_f32_16x16x32_bf16 v[28:31], v[180:183], v[220:223], v[28:31]
  v_mfma_f32_16x16x32_bf16 v[24:27], v[180:183], v[216:219], v[24:27]
  v_mfma_f32_16x16x32_bf16 v[20:23], v[180:183], v[212:215], v[20:23]
  v_mfma_f32_16x16x32_bf16 v[16:19], v[180:183], v[208:211], v[16:19]
  v_mfma_f32_16x16x32_bf16 v[32:35], v[184:187], v[208:211], v[32:35]
  v_mfma_f32_16x16x32_bf16 v[36:39], v[184:187], v[212:215], v[36:39]
  v_mfma_f32_16x16x32_bf16 v[40:43], v[184:187], v[216:219], v[40:43]
  v_mfma_f32_16x16x32_bf16 v[44:47], v[184:187], v[220:223], v[44:47]
  v_mfma_f32_16x16x32_bf16 v[60:63], v[188:191], v[220:223], v[60:63]
  v_mfma_f32_16x16x32_bf16 v[56:59], v[188:191], v[216:219], v[56:59]
  v_mfma_f32_16x16x32_bf16 v[52:55], v[188:191], v[212:215], v[52:55]
  v_mfma_f32_16x16x32_bf16 v[48:51], v[188:191], v[208:211], v[48:51]
  s_add_u32 s50, s94, 24576
  buffer_load_dwordx4 v[208:211], v252, s[36:39], s50 offen offset:0 sc1
  buffer_load_dwordx4 v[212:215], v252, s[36:39], s50 offen offset:1024 sc1
  buffer_load_dwordx4 v[216:219], v252, s[36:39], s50 offen offset:2048 sc1
  buffer_load_dwordx4 v[220:223], v252, s[36:39], s50 offen offset:3072 sc1
  ds_read_b64_tr_b16 v[176:177], v250 offset:29568
  ds_read_b64_tr_b16 v[178:179], v250 offset:30080
  ds_read_b64_tr_b16 v[180:181], v250 offset:29600
  ds_read_b64_tr_b16 v[182:183], v250 offset:30112
  ds_read_b64_tr_b16 v[184:185], v250 offset:29632
  ds_read_b64_tr_b16 v[186:187], v250 offset:30144
  ds_read_b64_tr_b16 v[188:189], v250 offset:29664
  ds_read_b64_tr_b16 v[190:191], v250 offset:30176
  s_waitcnt vmcnt(8)
  s_waitcnt lgkmcnt(15)
  v_mfma_f32_16x16x32_bf16 v[0:3], v[64:67], v[224:227], v[0:3]
  v_mfma_f32_16x16x32_bf16 v[4:7], v[64:67], v[228:231], v[4:7]
  v_mfma_f32_16x16x32_bf16 v[8:11], v[64:67], v[232:235], v[8:11]
  v_mfma_f32_16x16x32_bf16 v[12:15], v[64:67], v[236:239], v[12:15]
  v_mfma_f32_16x16x32_bf16 v[28:31], v[68:71], v[236:239], v[28:31]
  v_mfma_f32_16x16x32_bf16 v[24:27], v[68:71], v[232:235], v[24:27]
  v_mfma_f32_16x16x32_bf16 v[20:23], v[68:71], v[228:231], v[20:23]
  v_mfma_f32_16x16x32_bf16 v[16:19], v[68:71], v[224:227], v[16:19]
  v_mfma_f32_16x16x32_bf16 v[32:35], v[72:75], v[224:227], v[32:35]
  v_mfma_f32_16x16x32_bf16 v[36:39], v[72:75], v[228:231], v[36:39]
  v_mfma_f32_16x16x32_bf16 v[40:43], v[72:75], v[232:235], v[40:43]
  v_mfma_f32_16x16x32_bf16 v[44:47], v[72:75], v[236:239], v[44:47]
  v_mfma_f32_16x16x32_bf16 v[60:63], v[76:79], v[236:239], v[60:63]
  v_mfma_f32_16x16x32_bf16 v[56:59], v[76:79], v[232:235], v[56:59]
  v_mfma_f32_16x16x32_bf16 v[52:55], v[76:79], v[228:231], v[52:55]
  v_mfma_f32_16x16x32_bf16 v[48:51], v[76:79], v[224:227], v[48:51]
  s_add_u32 s50, s94, 36864
  buffer_load_dwordx4 v[224:227], v252, s[36:39], s50 offen offset:0 sc1
  buffer_load_dwordx4 v[228:231], v252, s[36:39], s50 offen offset:1024 sc1
  buffer_load_dwordx4 v[232:235], v252, s[36:39], s50 offen offset:2048 sc1
  buffer_load_dwordx4 v[236:239], v252, s[36:39], s50 offen offset:3072 sc1
  s_waitcnt vmcnt(8)
  v_mfma_f32_16x16x32_bf16 v[0:3], v[80:83], v[192:195], v[0:3]
  v_mfma_f32_16x16x32_bf16 v[4:7], v[80:83], v[196:199], v[4:7]
  v_mfma_f32_16x16x32_bf16 v[8:11], v[80:83], v[200:203], v[8:11]
  v_mfma_f32_16x16x32_bf16 v[12:15], v[80:83], v[204:207], v[12:15]
  v_mfma_f32_16x16x32_bf16 v[28:31], v[84:87], v[204:207], v[28:31]
  v_mfma_f32_16x16x32_bf16 v[24:27], v[84:87], v[200:203], v[24:27]
  v_mfma_f32_16x16x32_bf16 v[20:23], v[84:87], v[196:199], v[20:23]
  v_mfma_f32_16x16x32_bf16 v[16:19], v[84:87], v[192:195], v[16:19]
  v_mfma_f32_16x16x32_bf16 v[32:35], v[88:91], v[192:195], v[32:35]
  v_mfma_f32_16x16x32_bf16 v[36:39], v[88:91], v[196:199], v[36:39]
  v_mfma_f32_16x16x32_bf16 v[40:43], v[88:91], v[200:203], v[40:43]
  v_mfma_f32_16x16x32_bf16 v[44:47], v[88:91], v[204:207], v[44:47]
  v_mfma_f32_16x16x32_bf16 v[60:63], v[92:95], v[204:207], v[60:63]
  v_mfma_f32_16x16x32_bf16 v[56:59], v[92:95], v[200:203], v[56:59]
  v_mfma_f32_16x16x32_bf16 v[52:55], v[92:95], v[196:199], v[52:55]
  v_mfma_f32_16x16x32_bf16 v[48:51], v[92:95], v[192:195], v[48:51]
  s_add_u32 s51, s100, 3
  s_and_b32 s51, s51, 3
  s_add_u32 s51, s51, s99
L_rchk3:
  s_bitcmp1_b32 s96, s51
  s_cbranch_scc0 L_rpoll3
  s_add_u32 s50, s95, 0
  buffer_load_dwordx4 v[192:195], v252, s[36:39], s50 offen offset:0 sc1
  buffer_load_dwordx4 v[196:199], v252, s[36:39], s50 offen offset:1024 sc1
  buffer_load_dwordx4 v[200:203], v252, s[36:39], s50 offen offset:2048 sc1
  buffer_load_dwordx4 v[204:207], v252, s[36:39], s50 offen offset:3072 sc1
  s_waitcnt vmcnt(8)
  v_mfma_f32_16x16x32_bf16 v[0:3], v[96:99], v[208:211], v[0:3]
  v_mfma_f32_16x16x32_bf16 v[4:7], v[96:99], v[212:215], v[4:7]
  v_mfma_f32_16x16x32_bf16 v[8:11], v[96:99], v[216:219], v[8:11]
  v_mfma_f32_16x16x32_bf16 v[12:15], v[96:99], v[220:223], v[12:15]
  v_mfma_f32_16x16x32_bf16 v[28:31], v[100:103], v[220:223], v[28:31]
  v_mfma_f32_16x16x32_bf16 v[24:27], v[100:103], v[216:219], v[24:27]
  v_mfma_f32_16x16x32_bf16 v[20:23], v[100:103], v[212:215], v[20:23]
  v_mfma_f32_16x16x32_bf16 v[16:19], v[100:103], v[208:211], v[16:19]
  v_mfma_f32_16x16x32_bf16 v[32:35], v[104:107], v[208:211], v[32:35]
  v_mfma_f32_16x16x32_bf16 v[36:39], v[104:107], v[212:215], v[36:39]
  v_mfma_f32_16x16x32_bf16 v[40:43], v[104:107], v[216:219], v[40:43]
  v_mfma_f32_16x16x32_bf16 v[44:47], v[104:107], v[220:223], v[44:47]
  v_mfma_f32_16x16x32_bf16 v[60:63], v[108:111], v[220:223], v[60:63]
  v_mfma_f32_16x16x32_bf16 v[56:59], v[108:111], v[216:219], v[56:59]
  v_mfma_f32_16x16x32_bf16 v[52:55], v[108:111], v[212:215], v[52:55]
  v_mfma_f32_16x16x32_bf16 v[48:51], v[108:111], v[208:211], v[48:51]
  s_add_u32 s50, s95, 12288
  buffer_load_dwordx4 v[208:211], v252, s[36:39], s50 offen offset:0 sc1
  buffer_load_dwordx4 v[212:215], v252, s[36:39], s50 offen offset:1024 sc1
  buffer_load_dwordx4 v[216:219], v252, s[36:39], s50 offen offset:2048 sc1
  buffer_load_dwordx4 v[220:223], v252, s[36:39], s50 offen offset:3072 sc1
  s_waitcnt vmcnt(8)
  v_mfma_f32_16x16x32_bf16 v[0:3], v[112:115], v[224:227], v[0:3]
  v_mfma_f32_16x16x32_bf16 v[4:7], v[112:115], v[228:231], v[4:7]
  v_mfma_f32_16x16x32_bf16 v[8:11], v[112:115], v[232:235], v[8:11]
  v_mfma_f32_16x16x32_bf16 v[12:15], v[112:115], v[236:239], v[12:15]
  v_mfma_f32_16x16x32_bf16 v[28:31], v[116:119], v[236:239], v[28:31]
  v_mfma_f32_16x16x32_bf16 v[24:27], v[116:119], v[232:235], v[24:27]
  v_mfma_f32_16x16x32_bf16 v[20:23], v[116:119], v[228:231], v[20:23]
  v_mfma_f32_16x16x32_bf16 v[16:19], v[116:119], v[224:227], v[16:19]
  v_mfma_f32_16x16x32_bf16 v[32:35], v[120:123], v[224:227], v[32:35]
  v_mfma_f32_16x16x32_bf16 v[36:39], v[120:123], v[228:231], v[36:39]
  v_mfma_f32_16x16x32_bf16 v[40:43], v[120:123], v[232:235], v[40:43]
  v_mfma_f32_16x16x32_bf16 v[44:47], v[120:123], v[236:239], v[44:47]
  v_mfma_f32_16x16x32_bf16 v[60:63], v[124:127], v[236:239], v[60:63]
  v_mfma_f32_16x16x32_bf16 v[56:59], v[124:127], v[232:235], v[56:59]
  v_mfma_f32_16x16x32_bf16 v[52:55], v[124:127], v[228:231], v[52:55]
  v_mfma_f32_16x16x32_bf16 v[48:51], v[124:127], v[224:227], v[48:51]
  s_add_u32 s50, s95, 24576
  buffer_load_dwordx4 v[224:227], v252, s[36:39], s50 offen offset:0 sc1
  buffer_load_dwordx4 v[228:231], v252, s[36:39], s50 offen offset:1024 sc1
  buffer_load_dwordx4 v[232:235], v252, s[36:39], s50 offen offset:2048 sc1
  buffer_load_dwordx4 v[236:239], v252, s[36:39], s50 offen offset:3072 sc1
  s_waitcnt vmcnt(8)
  v_mfma_f32_16x16x32_bf16 v[0:3], v[128:131], v[192:195], v[0:3]
  v_mfma_f32_16x16x32_bf16 v[4:7], v[128:131], v[196:199], v[4:7]
  v_mfma_f32_16x16x32_bf16 v[8:11], v[128:131], v[200:203], v[8:11]
  v_mfma_f32_16x16x32_bf16 v[12:15], v[128:131], v[204:207], v[12:15]
  v_mfma_f32_16x16x32_bf16 v[28:31], v[132:135], v[204:207], v[28:31]
  v_mfma_f32_16x16x32_bf16 v[24:27], v[132:135], v[200:203], v[24:27]
  v_mfma_f32_16x16x32_bf16 v[20:23], v[132:135], v[196:199], v[20:23]
  v_mfma_f32_16x16x32_bf16 v[16:19], v[132:135], v[192:195], v[16:19]
  v_mfma_f32_16x16x32_bf16 v[32:35], v[136:139], v[192:195], v[32:35]
  v_mfma_f32_16x16x32_bf16 v[36:39], v[136:139], v[196:199], v[36:39]
  v_mfma_f32_16x16x32_bf16 v[40:43], v[136:139], v[200:203], v[40:43]
  v_mfma_f32_16x16x32_bf16 v[44:47], v[136:139], v[204:207], v[44:47]
  v_mfma_f32_16x16x32_bf16 v[60:63], v[140:143], v[204:207], v[60:63]
  v_mfma_f32_16x16x32_bf16 v[56:59], v[140:143], v[200:203], v[56:59]
  v_mfma_f32_16x16x32_bf16 v[52:55], v[140:143], v[196:199], v[52:55]
  v_mfma_f32_16x16x32_bf16 v[48:51], v[140:143], v[192:195], v[48:51]
  s_add_u32 s50, s95, 36864
  buffer_load_dwordx4 v[192:195], v252, s[36:39], s50 offen offset:0 sc1
  buffer_load_dwordx4 v[196:199], v252, s[36:39], s50 offen offset:1024 sc1
  buffer_load_dwordx4 v[200:203], v252, s[36:39], s50 offen offset:2048 sc1
  buffer_load_dwordx4 v[204:207], v252, s[36:39], s50 offen offset:3072 sc1
  s_waitcnt vmcnt(8)
  v_mfma_f32_16x16x32_bf16 v[0:3], v[144:147], v[208:211], v[0:3]
  v_mfma_f32_16x16x32_bf16 v[4:7], v[144:147], v[212:215], v[4:7]
  v_mfma_f32_16x16x32_bf16 v[8:11], v[144:147], v[216:219], v[8:11]
  v_mfma_f32_16x16x32_bf16 v[12:15], v[144:147], v[220:223], v[12:15]
  v_mfma_f32_16x16x32_bf16 v[28:31], v[148:151], v[220:223], v[28:31]
  v_mfma_f32_16x16x32_bf16 v[24:27], v[148:151], v[216:219], v[24:27]
  v_mfma_f32_16x16x32_bf16 v[20:23], v[148:151], v[212:215], v[20:23]
  v_mfma_f32_16x16x32_bf16 v[16:19], v[148:151], v[208:211], v[16:19]
  v_mfma_f32_16x16x32_bf16 v[32:35], v[152:155], v[208:211], v[32:35]
  v_mfma_f32_16x16x32_bf16 v[36:39], v[152:155], v[212:215], v[36:39]
  v_mfma_f32_16x16x32_bf16 v[40:43], v[152:155], v[216:219], v[40:43]
  v_mfma_f32_16x16x32_bf16 v[44:47], v[152:155], v[220:223], v[44:47]
  v_mfma_f32_16x16x32_bf16 v[60:63], v[156:159], v[220:223], v[60:63]
  v_mfma_f32_16x16x32_bf16 v[56:59], v[156:159], v[216:219], v[56:59]
  v_mfma_f32_16x16x32_bf16 v[52:55], v[156:159], v[212:215], v[52:55]
  v_mfma_f32_16x16x32_bf16 v[48:51], v[156:159], v[208:211], v[48:51]
  s_waitcnt vmcnt(4)
  s_waitcnt lgkmcnt(8)
  v_mfma_f32_16x16x32_bf16 v[0:3], v[160:163], v[224:227], v[0:3]
  v_mfma_f32_16x16x32_bf16 v[4:7], v[160:163], v[228:231], v[4:7]
  v_mfma_f32_16x16x32_bf16 v[8:11], v[160:163], v[232:235], v[8:11]
  v_mfma_f32_16x16x32_bf16 v[12:15], v[160:163], v[236:239], v[12:15]
  v_mfma_f32_16x16x32_bf16 v[28:31], v[164:167], v[236:239], v[28:31]
  v_mfma_f32_16x16x32_bf16 v[24:27], v[164:167], v[232:235], v[24:27]
  v_mfma_f32_16x16x32_bf16 v[20:23], v[164:167], v[228:231], v[20:23]
  v_mfma_f32_16x16x32_bf16 v[16:19], v[164:167], v[224:227], v[16:19]
  v_mfma_f32_16x16x32_bf16 v[32:35], v[168:171], v[224:227], v[32:35]
  v_mfma_f32_16x16x32_bf16 v[36:39], v[168:171], v[228:231], v[36:39]
  v_mfma_f32_16x16x32_bf16 v[40:43], v[168:171], v[232:235], v[40:43]
  v_mfma_f32_16x16x32_bf16 v[44:47], v[168:171], v[236:239], v[44:47]
  v_mfma_f32_16x16x32_bf16 v[60:63], v[172:175], v[236:239], v[60:63]
  v_mfma_f32_16x16x32_bf16 v[56:59], v[172:175], v[232:235], v[56:59]
  v_mfma_f32_16x16x32_bf16 v[52:55], v[172:175], v[228:231], v[52:55]
  v_mfma_f32_16x16x32_bf16 v[48:51], v[172:175], v[224:227], v[48:51]
  s_waitcnt vmcnt(0)
  s_waitcnt lgkmcnt(0)
  v_mfma_f32_16x16x32_bf16 v[0:3], v[176:179], v[192:195], v[0:3]
  v_mfma_f32_16x16x32_bf16 v[4:7], v[176:179], v[196:199], v[4:7]
  v_mfma_f32_16x16x32_bf16 v[8:11], v[176:179], v[200:203], v[8:11]
  v_mfma_f32_16x16x32_bf16 v[12:15], v[176:179], v[204:207], v[12:15]
  v_mfma_f32_16x16x32_bf16 v[28:31], v[180:183], v[204:207], v[28:31]
  v_mfma_f32_16x16x32_bf16 v[24:27], v[180:183], v[200:203], v[24:27]
  v_mfma_f32_16x16x32_bf16 v[20:23], v[180:183], v[196:199], v[20:23]
  v_mfma_f32_16x16x32_bf16 v[16:19], v[180:183], v[192:195], v[16:19]
  v_mfma_f32_16x16x32_bf16 v[32:35], v[184:187], v[192:195], v[32:35]
  v_mfma_f32_16x16x32_bf16 v[36:39], v[184:187], v[196:199], v[36:39]
  v_mfma_f32_16x16x32_bf16 v[40:43], v[184:187], v[200:203], v[40:43]
  v_mfma_f32_16x16x32_bf16 v[44:47], v[184:187], v[204:207], v[44:47]
  v_mfma_f32_16x16x32_bf16 v[60:63], v[188:191], v[204:207], v[60:63]
  v_mfma_f32_16x16x32_bf16 v[56:59], v[188:191], v[200:203], v[56:59]
  v_mfma_f32_16x16x32_bf16 v[52:55], v[188:191], v[196:199], v[52:55]
  v_mfma_f32_16x16x32_bf16 v[48:51], v[188:191], v[192:195], v[48:51]
  s_lshr_b32 s50, s62, 2
  s_mul_i32 s49, s50, 16896
  s_add_u32 s49, s49, s84
  v_lshrrev_b32 v249, 2, v252
  v_and_b32 v249, 0xc0, v249
  v_add_u32 v249, v249, v252
  v_and_b32 v249, 0xf0, v249
  v_and_b32 v248, 0x300, v252
  v_add3_u32 v250, v248, v249, s49
  s_lshl_b32 s50, s50, 8
  v_add_u32 v244, s50, v245
L_pw:
  s_sub_u32 s63, s63, 1
  s_cbranch_scc1 L_end
  ds_read_b32 v249, v244 offset:0
  s_waitcnt lgkmcnt(0)
  v_cmp_gt_u32 vcc, 0x100001, v249
  s_nop 1
  s_cbranch_vccz L_pw_d
  s_sleep 1
  s_branch L_pw
L_pw_d:
  ds_write_b128 v250, v[0:3] offset:0
  ds_write_b128 v250, v[4:7] offset:1024
  ds_write_b128 v250, v[8:11] offset:2048
  ds_write_b128 v250, v[12:15] offset:3072
  ds_write_b128 v250, v[16:19] offset:4096
  ds_write_b128 v250, v[20:23] offset:5120
  ds_write_b128 v250, v[24:27] offset:6144
  ds_write_b128 v250, v[28:31] offset:7168
  ds_write_b128 v250, v[32:35] offset:8192
  ds_write_b128 v250, v[36:39] offset:9216
  ds_write_b128 v250, v[40:43] offset:10240
  ds_write_b128 v250, v[44:47] offset:11264
  ds_write_b128 v250, v[48:51] offset:12288
  ds_write_b128 v250, v[52:55] offset:13312
  ds_write_b128 v250, v[56:59] offset:14336
  ds_write_b128 v250, v[60:63] offset:15360
  s_cmp_ge_u32 s62, 4
  s_cbranch_scc1 L_hfin
  s_and_b32 s49, s62, 3
  s_lshl_b32 s49, s49, 9
  v_add_u32 v247, s49, v254
  v_mov_b32 v246, 0x100001
  ds_write_b32 v247, v246 offset:256
  v_lshrrev_b32 v251, 4, v254
  v_bfe_u32 v249, v254, 2, 2
  v_lshl_add_u32 v248, v249, 2, v251
  v_and_b32 v248, 15, v248
  v_lshlrev_b32 v248, 4, v248
  v_lshl_add_u32 v248, v249, 8, v248
  v_mul_u32_u24 v251, 1280, v251
  v_lshl_add_u32 v251, v249, 3, v251
  s_lshl_b32 s50, s62, 10
  s_add_u32 s50, s50, 2048
  v_add_u32 v248, s50, v248
  v_add_u32 v243, 67584, v248
L_cw:
  s_sub_u32 s63, s63, 1
  s_cbranch_scc1 L_end
  ds_read_b32 v249, v245 offset:256
  s_waitcnt lgkmcnt(0)
  v_cmp_gt_u32 vcc, 0x100001, v249
  s_nop 1
  s_cbranch_vccz L_cw_d
  s_sleep 1
  s_branch L_cw
L_cw_d:
  ds_read_b128 v[64:67], v248 offset:0
  ds_read_b128 v[68:71], v248 offset:33792
  ds_read_b128 v[72:75], v243 offset:0
  ds_read_b128 v[76:79], v243 offset:33792
  ds_read_b128 v[80:83], v248 offset:4096
  ds_read_b128 v[84:87], v248 offset:37888
  ds_read_b128 v[88:91], v243 offset:4096
  ds_read_b128 v[92:95], v243 offset:37888
  ds_read_b128 v[96:99], v248 offset:8192
  ds_read_b128 v[100:103], v248 offset:41984
  ds_read_b128 v[104:107], v243 offset:8192
  ds_read_b128 v[108:111], v243 offset:41984
  ds_read_b128 v[112:115], v248 offset:12288
  ds_read_b128 v[116:119], v248 offset:46080
  ds_read_b128 v[120:123], v243 offset:12288
  ds_read_b128 v[124:127], v243 offset:46080
  s_waitcnt lgkmcnt(12)
  v_pk_add_f32 v[64:65], v[64:65], v[68:69]
  v_pk_add_f32 v[72:73], v[72:73], v[76:77]
  v_pk_add_f32 v[66:67], v[66:67], v[70:71]
  v_pk_add_f32 v[74:75], v[74:75], v[78:79]
  v_pk_add_f32 v[64:65], v[64:65], v[72:73]
  v_pk_add_f32 v[66:67], v[66:67], v[74:75]
  buffer_store_dwordx4 v[64:67], v252, s[36:39], s28 offen offset:0 sc1
  s_waitcnt lgkmcnt(8)
  v_pk_add_f32 v[80:81], v[80:81], v[84:85]
  v_pk_add_f32 v[88:89], v[88:89], v[92:93]
  v_pk_add_f32 v[82:83], v[82:83], v[86:87]
  v_pk_add_f32 v[90:91], v[90:91], v[94:95]
  v_pk_add_f32 v[80:81], v[80:81], v[88:89]
  v_pk_add_f32 v[82:83], v[82:83], v[90:91]
  buffer_store_dwordx4 v[80:83], v252, s[36:39], s28 offen offset:1024 sc1
  s_waitcnt lgkmcnt(4)
  v_pk_add_f32 v[96:97], v[96:97], v[100:101]
  v_pk_add_f32 v[104:105], v[104:105], v[108:109]
  v_pk_add_f32 v[98:99], v[98:99], v[102:103]
  v_pk_add_f32 v[106:107], v[106:107], v[110:111]
  v_pk_add_f32 v[96:97], v[96:97], v[104:105]
  v_pk_add_f32 v[98:99], v[98:99], v[106:107]
  buffer_store_dwordx4 v[96:99], v252, s[36:39], s28 offen offset:2048 sc1
  s_waitcnt lgkmcnt(0)
  v_pk_add_f32 v[112:113], v[112:113], v[116:117]
  v_pk_add_f32 v[120:121], v[120:121], v[124:125]
  v_pk_add_f32 v[114:115], v[114:115], v[118:119]
  v_pk_add_f32 v[122:123], v[122:123], v[126:127]
  v_pk_add_f32 v[112:113], v[112:113], v[120:121]
  v_pk_add_f32 v[114:115], v[114:115], v[122:123]
  buffer_store_dwordx4 v[112:115], v252, s[36:39], s28 offen offset:3072 sc1
  s_add_u32 s30, s30, 1
  v_mov_b32 v0, 0
  v_mov_b32 v1, s30
  s_mov_b64 exec, 1
  s_waitcnt vmcnt(0)
  buffer_store_dword v1, v0, s[36:39], s29 offen offset:0 sc1
  s_mov_b64 exec, -1
  s_xor_b32 s29, s29, 512
  s_xor_b32 s28, s28, 16384
L_xp:
  s_sub_u32 s63, s63, 1
  s_cbranch_scc1 L_end
  buffer_load_dword v2, v0, s[36:39], s29 offen offset:0 sc1
  s_waitcnt vmcnt(0)
  v_cmp_ne_u32 vcc, s31, v2
  s_nop 1
  s_cbranch_vccnz L_xpd
  s_sleep 4
  s_branch L_xp
L_xpd:
  buffer_load_dwordx4 v[16:19], v252, s[36:39], s28 offen offset:0 sc1
  buffer_load_dwordx4 v[20:23], v252, s[36:39], s28 offen offset:1024 sc1
  buffer_load_dwordx4 v[24:27], v252, s[36:39], s28 offen offset:2048 sc1
  buffer_load_dwordx4 v[28:31], v252, s[36:39], s28 offen offset:3072 sc1
  s_barrier
  ds_read_b128 v[128:131], v248 offset:16896
  ds_read_b128 v[132:135], v248 offset:50688
  ds_read_b128 v[136:139], v243 offset:16896
  ds_read_b128 v[140:143], v243 offset:50688
  ds_read_b128 v[144:147], v248 offset:20992
  ds_read_b128 v[148:151], v248 offset:54784
  ds_read_b128 v[152:155], v243 offset:20992
  ds_read_b128 v[156:159], v243 offset:54784
  ds_read_b128 v[160:163], v248 offset:25088
  ds_read_b128 v[164:167], v248 offset:58880
  ds_read_b128 v[168:171], v243 offset:25088
  ds_read_b128 v[172:175], v243 offset:58880
  ds_read_b128 v[176:179], v248 offset:29184
  ds_read_b128 v[180:183], v248 offset:62976
  ds_read_b128 v[184:187], v243 offset:29184
  ds_read_b128 v[188:191], v243 offset:62976
  s_waitcnt vmcnt(0)
  s_waitcnt lgkmcnt(12)
  v_pk_add_f32 v[128:129], v[128:129], v[132:133]
  v_pk_add_f32 v[136:137], v[136:137], v[140:141]
  v_pk_add_f32 v[130:131], v[130:131], v[134:135]
  v_pk_add_f32 v[138:139], v[138:139], v[142:143]
  v_pk_add_f32 v[128:129], v[128:129], v[136:137]
  v_pk_add_f32 v[130:131], v[130:131], v[138:139]
  v_pk_add_f32 v[128:129], v[128:129], v[16:17]
  v_pk_add_f32 v[130:131], v[130:131], v[18:19]
  v_cvt_pk_bf16_f32 v40, v128, v129
  v_cvt_pk_bf16_f32 v41, v130, v131
  buffer_store_dwordx2 v[40:41], v251, s[80:83], s98 offen offset:0
  s_waitcnt lgkmcnt(8)
  v_pk_add_f32 v[144:145], v[144:145], v[148:149]
  v_pk_add_f32 v[152:153], v[152:153], v[156:157]
  v_pk_add_f32 v[146:147], v[146:147], v[150:151]
  v_pk_add_f32 v[154:155], v[154:155], v[158:159]
  v_pk_add_f32 v[144:145], v[144:145], v[152:153]
  v_pk_add_f32 v[146:147], v[146:147], v[154:155]
  v_pk_add_f32 v[144:145], v[144:145], v[20:21]
  v_pk_add_f32 v[146:147], v[146:147], v[22:23]
  v_cvt_pk_bf16_f32 v42, v144, v145
  v_cvt_pk_bf16_f32 v43, v146, v147
  buffer_store_dwordx2 v[42:43], v251, s[80:83], s98 offen offset:32
  s_waitcnt lgkmcnt(4)
  v_pk_add_f32 v[160:161], v[160:161], v[164:165]
  v_pk_add_f32 v[168:169], v[168:169], v[172:173]
  v_pk_add_f32 v[162:163], v[162:163], v[166:167]
  v_pk_add_f32 v[170:171], v[170:171], v[174:175]
  v_pk_add_f32 v[160:161], v[160:161], v[168:169]
  v_pk_add_f32 v[162:163], v[162:163], v[170:171]
  v_pk_add_f32 v[160:161], v[160:161], v[24:25]
  v_pk_add_f32 v[162:163], v[162:163], v[26:27]
  v_cvt_pk_bf16_f32 v44, v160, v161
  v_cvt_pk_bf16_f32 v45, v162, v163
  buffer_store_dwordx2 v[44:45], v251, s[80:83], s98 offen offset:64
  s_waitcnt lgkmcnt(0)
  v_pk_add_f32 v[176:177], v[176:177], v[180:181]
  v_pk_add_f32 v[184:185], v[184:185], v[188:189]
  v_pk_add_f32 v[178:179], v[178:179], v[182:183]
  v_pk_add_f32 v[186:187], v[186:187], v[190:191]
  v_pk_add_f32 v[176:177], v[176:177], v[184:185]
  v_pk_add_f32 v[178:179], v[178:179], v[186:187]
  v_pk_add_f32 v[176:177], v[176:177], v[28:29]
  v_pk_add_f32 v[178:179], v[178:179], v[30:31]
  v_cvt_pk_bf16_f32 v46, v176, v177
  v_cvt_pk_bf16_f32 v47, v178, v179
  buffer_store_dwordx2 v[46:47], v251, s[80:83], s98 offen offset:96
L_tail_done:
L_end:
  s_endpgm
L_kv_sel:
  s_cmp_gt_u32 s47, 4
  s_cbranch_scc1 L_kv_s0
  s_cmp_gt_u32 s47, 2
  s_cbranch_scc1 L_kv_s1
L_kv_s2:
  s_add_u32 m0, s52, 0
  s_nop 0
  buffer_load_dwordx4 v252, s[28:31], s53 offen offset:0 nt lds
  s_waitcnt vmcnt(15)
  s_add_i32 s49, s44, 127
  s_cmp_le_i32 s49, s55
  s_cbranch_scc1 L_kv_np2_16
  s_max_i32 s55, s55, s49
  v_mov_b32 v5, s55
  ds_write_b32 v3, v5
L_kv_np2_16:
  s_add_u32 m0, s52, 32
  s_nop 0
  buffer_load_dwordx4 v252, s[28:31], s53 offen offset:1024 nt lds
  v_and_b32 v7, 15, v6
  v_cmp_gt_u32 vcc, 9, v7
  s_sub_u32 s47, s47, 1
  s_max_i32 s50, s48, 0
  s_max_i32 s47, s47, s50
  s_or_b32 s49, vcc_lo, s51
  s_mov_b32 s51, vcc_lo
  s_cbranch_scc1 L_kv_ok16
  s_cmp_lt_i32 s47, 4
  s_cselect_b32 s50, 2, 0
  s_add_i32 s48, s48, s50
  s_mov_b32 s47, 6
L_kv_ok16:
  s_waitcnt vmcnt(15)
  s_add_u32 m0, s52, 64
  s_nop 0
  buffer_load_dwordx4 v252, s[28:31], s53 offen offset:2048 nt lds
  s_waitcnt vmcnt(15)
  s_add_u32 m0, s52, 96
  s_nop 0
  buffer_load_dwordx4 v252, s[28:31], s53 offen offset:3072 nt lds
  s_add_u32 s53, s53, 4096
  s_waitcnt vmcnt(15)
  s_add_u32 m0, s52, 4224
  s_nop 0
  buffer_load_dwordx4 v252, s[28:31], s53 offen offset:0 nt lds
  s_waitcnt vmcnt(15)
  s_add_u32 m0, s52, 4256
  s_nop 0
  buffer_load_dwordx4 v252, s[28:31], s53 offen offset:1024 nt lds
  s_waitcnt vmcnt(15)
  s_add_u32 m0, s52, 4288
  s_nop 0
  buffer_load_dwordx4 v252, s[28:31], s53 offen offset:2048 nt lds
  s_waitcnt vmcnt(15)
  s_add_u32 m0, s52, 4320
  s_nop 0
  buffer_load_dwordx4 v252, s[28:31], s53 offen offset:3072 nt lds
  s_add_u32 s53, s53, 4096
  s_waitcnt vmcnt(15)
  s_add_u32 m0, s52, 16896
  s_nop 0
  buffer_load_dwordx4 v252, s[28:31], s53 offen offset:0 nt lds
  s_waitcnt vmcnt(15)
  s_add_u32 m0, s52, 16928
  s_nop 0
  buffer_load_dwordx4 v252, s[28:31], s53 offen offset:1024 nt lds
  s_waitcnt vmcnt(15)
  s_add_u32 m0, s52, 16960
  s_nop 0
  buffer_load_dwordx4 v252, s[28:31], s53 offen offset:2048 nt lds
  s_waitcnt vmcnt(15)
  s_add_u32 m0, s52, 16992
  s_nop 0
  buffer_load_dwordx4 v252, s[28:31], s53 offen offset:3072 nt lds
  s_add_u32 s53, s53, 4096
  s_waitcnt vmcnt(15)
  s_add_u32 m0, s52, 21120
  s_nop 0
  buffer_load_dwordx4 v252, s[28:31], s53 offen offset:0 nt lds
  s_waitcnt vmcnt(15)
  s_add_u32 m0, s52, 21152
  s_nop 0
  buffer_load_dwordx4 v252, s[28:31], s53 offen offset:1024 nt lds
  s_waitcnt vmcnt(15)
  s_add_u32 m0, s52, 21184
  s_nop 0
  buffer_load_dwordx4 v252, s[28:31], s53 offen offset:2048 nt lds
  s_waitcnt vmcnt(15)
  s_add_i32 s49, s44, 128
  s_max_i32 s55, s55, s49
  v_mov_b32 v5, s55
  ds_write_b32 v3, v5
  s_add_u32 m0, s52, 21216
  s_nop 0
  buffer_load_dwordx4 v252, s[28:31], s53 offen offset:3072 nt lds
  s_add_u32 s53, s53, 4096
  s_waitcnt vmcnt(15)
  s_add_u32 m0, s52, 8448
  s_nop 0
  buffer_load_dwordx4 v252, s[76:79], s46 offen offset:0 nt lds
  s_waitcnt vmcnt(15)
  s_add_u32 m0, s52, 8480
  s_nop 0
  buffer_load_dwordx4 v252, s[76:79], s46 offen offset:1024 nt lds
  s_waitcnt vmcnt(15)
  s_add_u32 m0, s52, 8512
  s_nop 0
  buffer_load_dwordx4 v252, s[76:79], s46 offen offset:2048 nt lds
  s_waitcnt vmcnt(15)
  s_add_u32 m0, s52, 8544
  s_nop 0
  buffer_load_dwordx4 v252, s[76:79], s46 offen offset:3072 nt lds
  s_add_u32 s46, s46, 4096
  s_waitcnt vmcnt(15)
  s_add_u32 m0, s52, 12672
  s_nop 0
  buffer_load_dwordx4 v252, s[76:79], s46 offen offset:0 nt lds
  s_waitcnt vmcnt(15)
  s_add_u32 m0, s52, 12704
  s_nop 0
  buffer_load_dwordx4 v252, s[76:79], s46 offen offset:1024 nt lds
  s_waitcnt vmcnt(15)
  s_add_u32 m0, s52, 12736
  s_nop 0
  buffer_load_dwordx4 v252, s[76:79], s46 offen offset:2048 nt lds
  s_waitcnt vmcnt(15)
  s_add_u32 m0, s52, 12768
  s_nop 0
  buffer_load_dwordx4 v252, s[76:79], s46 offen offset:3072 nt lds
  s_add_u32 s46, s46, 4096
  s_waitcnt vmcnt(15)
  s_add_u32 m0, s52, 25344
  s_nop 0
  buffer_load_dwordx4 v252, s[76:79], s46 offen offset:0 nt lds
  s_waitcnt vmcnt(15)
  s_add_u32 m0, s52, 25376
  s_nop 0
  buffer_load_dwordx4 v252, s[76:79], s46 offen offset:1024 nt lds
  s_waitcnt vmcnt(15)
  s_add_u32 m0, s52, 25408
  s_nop 0
  buffer_load_dwordx4 v252, s[76:79], s46 offen offset:2048 nt lds
  s_waitcnt vmcnt(15)
  s_add_u32 m0, s52, 25440
  s_nop 0
  buffer_load_dwordx4 v252, s[76:79], s46 offen offset:3072 nt lds
  s_add_u32 s46, s46, 4096
  s_waitcnt vmcnt(15)
  s_add_u32 m0, s52, 29568
  s_nop 0
  buffer_load_dwordx4 v252, s[76:79], s46 offen offset:0 nt lds
  s_waitcnt vmcnt(15)
  s_add_u32 m0, s52, 29600
  s_nop 0
  buffer_load_dwordx4 v252, s[76:79], s46 offen offset:1024 nt lds
  s_waitcnt vmcnt(15)
  s_add_u32 m0, s52, 29632
  s_nop 0
  buffer_load_dwordx4 v252, s[76:79], s46 offen offset:2048 nt lds
  s_waitcnt vmcnt(15)
  s_add_i32 s49, s44, 129
  s_max_i32 s55, s55, s49
  v_mov_b32 v5, s55
  ds_write_b32 v3, v5
  s_add_u32 m0, s52, 29664
  s_nop 0
  buffer_load_dwordx4 v252, s[76:79], s46 offen offset:3072 nt lds
  s_add_u32 s46, s46, 4096
  s_waitcnt vmcnt(15)
  s_branch L_kv_meas
L_kv_s1:
  s_add_u32 m0, s52, 0
  s_nop 0
  buffer_load_dwordx4 v252, s[28:31], s53 offen offset:0 nt lds
  s_waitcnt vmcnt(14)
  s_add_i32 s49, s44, 127
  s_cmp_le_i32 s49, s55
  s_cbranch_scc1 L_kv_np2_15
  s_max_i32 s55, s55, s49
  v_mov_b32 v5, s55
  ds_write_b32 v3, v5
L_kv_np2_15:
  s_add_u32 m0, s52, 32
  s_nop 0
  buffer_load_dwordx4 v252, s[28:31], s53 offen offset:1024 nt lds
  v_and_b32 v7, 15, v6
  v_cmp_gt_u32 vcc, 9, v7
  s_sub_u32 s47, s47, 1
  s_max_i32 s50, s48, 0
  s_max_i32 s47, s47, s50
  s_or_b32 s49, vcc_lo, s51
  s_mov_b32 s51, vcc_lo
  s_cbranch_scc1 L_kv_ok15
  s_cmp_lt_i32 s47, 4
  s_cselect_b32 s50, 2, 0
  s_add_i32 s48, s48, s50
  s_mov_b32 s47, 6
L_kv_ok15:
  s_waitcnt vmcnt(14)
  s_add_u32 m0, s52, 64
  s_nop 0
  buffer_load_dwordx4 v252, s[28:31], s53 offen offset:2048 nt lds
  s_waitcnt vmcnt(14)
  s_add_u32 m0, s52, 96
  s_nop 0
  buffer_load_dwordx4 v252, s[28:31], s53 offen offset:3072 nt lds
  s_add_u32 s53, s53, 4096
  s_waitcnt vmcnt(14)
  s_add_u32 m0, s52, 4224
  s_nop 0
  buffer_load_dwordx4 v252, s[28:31], s53 offen offset:0 nt lds
  s_waitcnt vmcnt(14)
  s_add_u32 m0, s52, 4256
  s_nop 0
  buffer_load_dwordx4 v252, s[28:31], s53 offen offset:1024 nt lds
  s_waitcnt vmcnt(14)
  s_add_u32 m0, s52, 4288
  s_nop 0
  buffer_load_dwordx4 v252, s[28:31], s53 offen offset:2048 nt lds
  s_waitcnt vmcnt(14)
  s_add_u32 m0, s52, 4320
  s_nop 0
  buffer_load_dwordx4 v252, s[28:31], s53 offen offset:3072 nt lds
  s_add_u32 s53, s53, 4096
  s_waitcnt vmcnt(14)
  s_add_u32 m0, s52, 16896
  s_nop 0
  buffer_load_dwordx4 v252, s[28:31], s53 offen offset:0 nt lds
  s_waitcnt vmcnt(14)
  s_add_u32 m0, s52, 16928
  s_nop 0
  buffer_load_dwordx4 v252, s[28:31], s53 offen offset:1024 nt lds
  s_waitcnt vmcnt(14)
  s_add_u32 m0, s52, 16960
  s_nop 0
  buffer_load_dwordx4 v252, s[28:31], s53 offen offset:2048 nt lds
  s_waitcnt vmcnt(14)
  s_add_u32 m0, s52, 16992
  s_nop 0
  buffer_load_dwordx4 v252, s[28:31], s53 offen offset:3072 nt lds
  s_add_u32 s53, s53, 4096
  s_waitcnt vmcnt(14)
  s_add_u32 m0, s52, 21120
  s_nop 0
  buffer_load_dwordx4 v252, s[28:31], s53 offen offset:0 nt lds
  s_waitcnt vmcnt(14)
  s_add_u32 m0, s52, 21152
  s_nop 0
  buffer_load_dwordx4 v252, s[28:31], s53 offen offset:1024 nt lds
  s_waitcnt vmcnt(14)
  s_add_i32 s49, s44, 128
  s_max_i32 s55, s55, s49
  v_mov_b32 v5, s55
  ds_write_b32 v3, v5
  s_add_u32 m0, s52, 21184
  s_nop 0
  buffer_load_dwordx4 v252, s[28:31], s53 offen offset:2048 nt lds
  s_waitcnt vmcnt(14)
  s_add_u32 m0, s52, 21216
  s_nop 0
  buffer_load_dwordx4 v252, s[28:31], s53 offen offset:3072 nt lds
  s_add_u32 s53, s53, 4096
  s_waitcnt vmcnt(14)
  s_add_u32 m0, s52, 8448
  s_nop 0
  buffer_load_dwordx4 v252, s[76:79], s46 offen offset:0 nt lds
  s_waitcnt vmcnt(14)
  s_add_u32 m0, s52, 8480
  s_nop 0
  buffer_load_dwordx4 v252, s[76:79], s46 offen offset:1024 nt lds
  s_waitcnt vmcnt(14)
  s_add_u32 m0, s52, 8512
  s_nop 0
  buffer_load_dwordx4 v252, s[76:79], s46 offen offset:2048 nt lds
  s_waitcnt vmcnt(14)
  s_add_u32 m0, s52, 8544
  s_nop 0
  buffer_load_dwordx4 v252, s[76:79], s46 offen offset:3072 nt lds
  s_add_u32 s46, s46, 4096
  s_waitcnt vmcnt(14)
  s_add_u32 m0, s52, 12672
  s_nop 0
  buffer_load_dwordx4 v252, s[76:79], s46 offen offset:0 nt lds
  s_waitcnt vmcnt(14)
  s_add_u32 m0, s52, 12704
  s_nop 0
  buffer_load_dwordx4 v252, s[76:79], s46 offen offset:1024 nt lds
  s_waitcnt vmcnt(14)
  s_add_u32 m0, s52, 12736
  s_nop 0
  buffer_load_dwordx4 v252, s[76:79], s46 offen offset:2048 nt lds
  s_waitcnt vmcnt(14)
  s_add_u32 m0, s52, 12768
  s_nop 0
  buffer_load_dwordx4 v252, s[76:79], s46 offen offset:3072 nt lds
  s_add_u32 s46, s46, 4096
  s_waitcnt vmcnt(14)
  s_add_u32 m0, s52, 25344
  s_nop 0
  buffer_load_dwordx4 v252, s[76:79], s46 offen offset:0 nt lds
  s_waitcnt vmcnt(14)
  s_add_u32 m0, s52, 25376
  s_nop 0
  buffer_load_dwordx4 v252, s[76:79], s46 offen offset:1024 nt lds
  s_waitcnt vmcnt(14)
  s_add_u32 m0, s52, 25408
  s_nop 0
  buffer_load_dwordx4 v252, s[76:79], s46 offen offset:2048 nt lds
  s_waitcnt vmcnt(14)
  s_add_u32 m0, s52, 25440
  s_nop 0
  buffer_load_dwordx4 v252, s[76:79], s46 offen offset:3072 nt lds
  s_add_u32 s46, s46, 4096
  s_waitcnt vmcnt(14)
  s_add_u32 m0, s52, 29568
  s_nop 0
  buffer_load_dwordx4 v252, s[76:79], s46 offen offset:0 nt lds
  s_waitcnt vmcnt(14)
  s_add_u32 m0, s52, 29600
  s_nop 0
  buffer_load_dwordx4 v252, s[76:79], s46 offen offset:1024 nt lds
  s_waitcnt vmcnt(14)
  s_add_i32 s49, s44, 129
  s_max_i32 s55, s55, s49
  v_mov_b32 v5, s55
  ds_write_b32 v3, v5
  s_add_u32 m0, s52, 29632
  s_nop 0
  buffer_load_dwordx4 v252, s[76:79], s46 offen offset:2048 nt lds
  s_waitcnt vmcnt(14)
  s_add_u32 m0, s52, 29664
  s_nop 0
  buffer_load_dwordx4 v252, s[76:79], s46 offen offset:3072 nt lds
  s_add_u32 s46, s46, 4096
  s_waitcnt vmcnt(14)
  s_branch L_kv_meas
L_kv_s0:
  s_add_u32 m0, s52, 0
  s_nop 0
  buffer_load_dwordx4 v252, s[28:31], s53 offen offset:0 nt lds
  s_waitcnt vmcnt(13)
  s_add_i32 s49, s44, 127
  s_cmp_le_i32 s49, s55
  s_cbranch_scc1 L_kv_np2_14
  s_max_i32 s55, s55, s49
  v_mov_b32 v5, s55
  ds_write_b32 v3, v5
L_kv_np2_14:
  s_add_u32 m0, s52, 32
  s_nop 0
  buffer_load_dwordx4 v252, s[28:31], s53 offen offset:1024 nt lds
  v_and_b32 v7, 15, v6
  v_cmp_gt_u32 vcc, 9, v7
  s_sub_u32 s47, s47, 1
  s_max_i32 s50, s48, 0
  s_max_i32 s47, s47, s50
  s_or_b32 s49, vcc_lo, s51
  s_mov_b32 s51, vcc_lo
  s_cbranch_scc1 L_kv_ok14
  s_cmp_lt_i32 s47, 4
  s_cselect_b32 s50, 2, 0
  s_add_i32 s48, s48, s50
  s_mov_b32 s47, 6
L_kv_ok14:
  s_waitcnt vmcnt(13)
  s_add_u32 m0, s52, 64
  s_nop 0
  buffer_load_dwordx4 v252, s[28:31], s53 offen offset:2048 nt lds
  s_waitcnt vmcnt(13)
  s_add_u32 m0, s52, 96
  s_nop 0
  buffer_load_dwordx4 v252, s[28:31], s53 offen offset:3072 nt lds
  s_add_u32 s53, s53, 4096
  s_waitcnt vmcnt(13)
  s_add_u32 m0, s52, 4224
  s_nop 0
  buffer_load_dwordx4 v252, s[28:31], s53 offen offset:0 nt lds
  s_waitcnt vmcnt(13)
  s_add_u32 m0, s52, 4256
  s_nop 0
  buffer_load_dwordx4 v252, s[28:31], s53 offen offset:1024 nt lds
  s_waitcnt vmcnt(13)
  s_add_u32 m0, s52, 4288
  s_nop 0
  buffer_load_dwordx4 v252, s[28:31], s53 offen offset:2048 nt lds
  s_waitcnt vmcnt(13)
  s_add_u32 m0, s52, 4320
  s_nop 0
  buffer_load_dwordx4 v252, s[28:31], s53 offen offset:3072 nt lds
  s_add_u32 s53, s53, 4096
  s_waitcnt vmcnt(13)
  s_add_u32 m0, s52, 16896
  s_nop 0
  buffer_load_dwordx4 v252, s[28:31], s53 offen offset:0 nt lds
  s_waitcnt vmcnt(13)
  s_add_u32 m0, s52, 16928
  s_nop 0
  buffer_load_dwordx4 v252, s[28:31], s53 offen offset:1024 nt lds
  s_waitcnt vmcnt(13)
  s_add_u32 m0, s52, 16960
  s_nop 0
  buffer_load_dwordx4 v252, s[28:31], s53 offen offset:2048 nt lds
  s_waitcnt vmcnt(13)
  s_add_u32 m0, s52, 16992
  s_nop 0
  buffer_load_dwordx4 v252, s[28:31], s53 offen offset:3072 nt lds
  s_add_u32 s53, s53, 4096
  s_waitcnt vmcnt(13)
  s_add_u32 m0, s52, 21120
  s_nop 0
  buffer_load_dwordx4 v252, s[28:31], s53 offen offset:0 nt lds
  s_waitcnt vmcnt(13)
  s_add_i32 s49, s44, 128
  s_max_i32 s55, s55, s49
  v_mov_b32 v5, s55
  ds_write_b32 v3, v5
  s_add_u32 m0, s52, 21152
  s_nop 0
  buffer_load_dwordx4 v252, s[28:31], s53 offen offset:1024 nt lds
  s_waitcnt vmcnt(13)
  s_add_u32 m0, s52, 21184
  s_nop 0
  buffer_load_dwordx4 v252, s[28:31], s53 offen offset:2048 nt lds
  s_waitcnt vmcnt(13)
  s_add_u32 m0, s52, 21216
  s_nop 0
  buffer_load_dwordx4 v252, s[28:31], s53 offen offset:3072 nt lds
  s_add_u32 s53, s53, 4096
  s_waitcnt vmcnt(13)
  s_add_u32 m0, s52, 8448
  s_nop 0
  buffer_load_dwordx4 v252, s[76:79], s46 offen offset:0 nt lds
  s_waitcnt vmcnt(13)
  s_add_u32 m0, s52, 8480
  s_nop 0
  buffer_load_dwordx4 v252, s[76:79], s46 offen offset:1024 nt lds
  s_waitcnt vmcnt(13)
  s_add_u32 m0, s52, 8512
  s_nop 0
  buffer_load_dwordx4 v252, s[76:79], s46 offen offset:2048 nt lds
  s_waitcnt vmcnt(13)
  s_add_u32 m0, s52, 8544
  s_nop 0
  buffer_load_dwordx4 v252, s[76:79], s46 offen offset:3072 nt lds
  s_add_u32 s46, s46, 4096
  s_waitcnt vmcnt(13)
  s_add_u32 m0, s52, 12672
  s_nop 0
  buffer_load_dwordx4 v252, s[76:79], s46 offen offset:0 nt lds
  s_waitcnt vmcnt(13)
  s_add_u32 m0, s52, 12704
  s_nop 0
  buffer_load_dwordx4 v252, s[76:79], s46 offen offset:1024 nt lds
  s_waitcnt vmcnt(13)
  s_add_u32 m0, s52, 12736
  s_nop 0
  buffer_load_dwordx4 v252, s[76:79], s46 offen offset:2048 nt lds
  s_waitcnt vmcnt(13)
  s_add_u32 m0, s52, 12768
  s_nop 0
  buffer_load_dwordx4 v252, s[76:79], s46 offen offset:3072 nt lds
  s_add_u32 s46, s46, 4096
  s_waitcnt vmcnt(13)
  s_add_u32 m0, s52, 25344
  s_nop 0
  buffer_load_dwordx4 v252, s[76:79], s46 offen offset:0 nt lds
  s_waitcnt vmcnt(13)
  s_add_u32 m0, s52, 25376
  s_nop 0
  buffer_load_dwordx4 v252, s[76:79], s46 offen offset:1024 nt lds
  s_waitcnt vmcnt(13)
  s_add_u32 m0, s52, 25408
  s_nop 0
  buffer_load_dwordx4 v252, s[76:79], s46 offen offset:2048 nt lds
  s_waitcnt vmcnt(13)
  s_add_u32 m0, s52, 25440
  s_nop 0
  buffer_load_dwordx4 v252, s[76:79], s46 offen offset:3072 nt lds
  s_add_u32 s46, s46, 4096
  s_waitcnt vmcnt(13)
  s_add_u32 m0, s52, 29568
  s_nop 0
  buffer_load_dwordx4 v252, s[76:79], s46 offen offset:0 nt lds
  s_waitcnt vmcnt(13)
  s_add_i32 s49, s44, 129
  s_max_i32 s55, s55, s49
  v_mov_b32 v5, s55
  ds_write_b32 v3, v5
  s_add_u32 m0, s52, 29600
  s_nop 0
  buffer_load_dwordx4 v252, s[76:79], s46 offen offset:1024 nt lds
  s_waitcnt vmcnt(13)
  s_add_u32 m0, s52, 29632
  s_nop 0
  buffer_load_dwordx4 v252, s[76:79], s46 offen offset:2048 nt lds
  s_waitcnt vmcnt(13)
  s_add_u32 m0, s52, 29664
  s_nop 0
  buffer_load_dwordx4 v252, s[76:79], s46 offen offset:3072 nt lds
  s_add_u32 s46, s46, 4096
  s_waitcnt vmcnt(13)
  s_branch L_kv_meas
.section .rodata,"a"
.p2align 6
.amdhsa_kernel standalone__mha_block_cached__near_ridge_kernel
  .amdhsa_next_free_vgpr 256
  .amdhsa_next_free_sgpr 102
  .amdhsa_accum_offset 256
  .amdhsa_group_segment_fixed_size 0
  .amdhsa_kernarg_size 64
  .amdhsa_user_sgpr_count 2
  .amdhsa_user_sgpr_kernarg_segment_ptr 1
  .amdhsa_system_sgpr_workgroup_id_x 1
.end_amdhsa_kernel
```
